```python
import torch

def _softmax(x, axis=-1):
    return torch.softmax(x, dim=axis)

def _gelu(x):
    return torch.nn.functional.gelu(x, approximate='tanh')

def _silu(x):
    return torch.nn.functional.silu(x)

def _sigmoid(x):
    return torch.sigmoid(x)

def _layernorm(x, axis=-1, eps=1e-05):
    m = x.mean(dim=axis, keepdim=True)
    v = x.var(dim=axis, keepdim=True, unbiased=False)
    return (x - m) / torch.sqrt(v + eps)

def _scatter_add(tgt, idx, src, axis=0):
    return tgt.clone().index_add_(axis, idx, src)

def _segment_sum(src, seg, n):
    out = torch.zeros((n,) + src.shape[1:], dtype=src.dtype)
    return out.index_add_(0, seg, src)

def _pad(x, pw):
    flat = tuple((v for pair in reversed(pw) for v in pair))
    return torch.nn.functional.pad(x, flat)
kernel_name = 'gated_mix__spectral_fnet__mixer_gmlp__prompt'

def setup_inputs():

    _w = lambda a: (lambda t: t.to(torch.bfloat16) if t.is_floating_point() else t)(torch.as_tensor(a))

    def _A_setup():
        B, S, D = (1, 2048, 448)
        ns = torch.arange(S)[:, None] * torch.arange(S)[None, :]
        nd = torch.arange(D)[:, None] * torch.arange(D)[None, :]
        Ws_re = torch.cos(-2.0 * torch.pi * ns / S).to(float)
        Ws_im = torch.sin(-2.0 * torch.pi * ns / S).to(float)
        Wd_re = torch.cos(-2.0 * torch.pi * nd / D).to(float)
        Wd_im = torch.sin(-2.0 * torch.pi * nd / D).to(float)
        return {'x': _w((lambda *s: torch.randn(*s, dtype=torch.bfloat16) * 0.05)(B, S, D)), 'dft_seq_re': _w(Ws_re), 'dft_seq_im': _w(Ws_im), 'dft_hid_re': _w(Wd_re), 'dft_hid_im': _w(Wd_im)}
    _A_in = _A_setup()

    def _B_setup():
        B, S, D, F = (1, 2048, 448, 1792)
        Fh = F // 2
        return {'x': _w((lambda *s: torch.randn(*s, dtype=torch.bfloat16) * 0.05)(B, S, D)), 'w_in': _w((lambda *s: torch.randn(*s, dtype=torch.bfloat16) * 0.8)(D, 2 * Fh)), 'w_sp': _w(0.01 * (lambda *s: torch.randn(*s, dtype=torch.bfloat16) * 0.8)(S, S)), 'b_sp': _w(1.0 + 0.01 * (lambda *s: torch.randn(*s, dtype=torch.bfloat16) * 0.8)(S)), 'w_out': _w((lambda *s: torch.randn(*s, dtype=torch.bfloat16) * 0.8)(Fh, D))}
    _B_in = _B_setup()
    return {'A_x': _A_in['x'], 'A_dft_seq_re': _A_in['dft_seq_re'], 'A_dft_seq_im': _A_in['dft_seq_im'], 'A_dft_hid_re': _A_in['dft_hid_re'], 'A_dft_hid_im': _A_in['dft_hid_im'], 'B_x': _B_in['x'], 'B_w_in': _B_in['w_in'], 'B_w_sp': _B_in['w_sp'], 'B_b_sp': _B_in['b_sp'], 'B_w_out': _B_in['w_out'], 'gate_w': _w((lambda *s: torch.randn(*s, dtype=torch.bfloat16) * 0.05)(448) * 16.0)}

def reference(A_x, A_dft_seq_re, A_dft_seq_im, A_dft_hid_re, A_dft_hid_im, B_x, B_w_in, B_w_sp, B_b_sp, B_w_out, gate_w):

    def _A_ref(x, dft_seq_re, dft_seq_im, dft_hid_re, dft_hid_im):
        a = torch.einsum('bsd,ed->bse', x, dft_hid_re)
        b = torch.einsum('bsd,ed->bse', x, dft_hid_im)
        y = torch.einsum('ts,bse->bte', dft_seq_re, a) - torch.einsum('ts,bse->bte', dft_seq_im, b)
        return y

    def _B_ref(x, w_in, w_sp, b_sp, w_out):
        B, S, D = x.shape
        F = w_in.shape[-1]
        Fh = F // 2
        z = _gelu(torch.einsum('bsd,df->bsf', x, w_in))
        z1 = z[..., :Fh].clone()
        z2 = _layernorm(z[..., Fh:], axis=-1)
        g = torch.einsum('ts,bsf->btf', w_sp, z2) + b_sp[None, :, None]
        return torch.einsum('bsf,fd->bsd', z1 * g, w_out)
    x = A_x
    g = _sigmoid((x * gate_w).sum(-1, keepdims=True))
    a = _A_ref(x, A_dft_seq_re, A_dft_seq_im, A_dft_hid_re, A_dft_hid_im)
    b = _B_ref(x, B_w_in, B_w_sp, B_b_sp, B_w_out)
    return g * a + (1 - g) * b
```

```asm
; @launch kernel=kf_kernel grid=(256,1,1) block=(448,1,1) lds=153600
.amdgcn_target "amdgcn-amd-amdhsa--gfx950"
.text
.globl kf_kernel
.p2align 8
.type kf_kernel,@function
kf_kernel:
    s_cmp_ge_u32 s2, 256
    s_cbranch_scc1 KF_END
    s_load_dwordx16 s[4:19], s[0:1], 0
    s_load_dwordx8 s[20:27], s[0:1], 64
    s_load_dwordx4 s[28:31], s[0:1], 96
    v_lshrrev_b32 v1, 6, v0
    v_and_b32 v2, 63, v0
    s_and_b32 s58, s2, 7
    v_readfirstlane_b32 s3, v1
    s_lshr_b32 s59, s2, 3
    s_lshl_b32 s56, s58, 2
    s_and_b32 s57, s59, 3
    s_add_u32 s56, s56, s57
    s_lshr_b32 s57, s59, 2
    s_and_b32 s60, s58, 1
    s_lshl_b32 s60, s60, 3
    s_and_b32 s61, s59, 7
    s_add_u32 s60, s60, s61
    s_lshr_b32 s61, s58, 1
    s_lshl_b32 s61, s61, 2
    s_lshr_b32 s62, s59, 3
    s_add_u32 s61, s61, s62
    s_cmp_lt_u32 s58, 4
    s_cselect_b32 s56, s56, s60
    s_cselect_b32 s57, s57, s61
    s_cselect_b32 s99, 0, 0
    s_mul_i32 s99, s99, s56
    s_and_b32 s99, s99, 31
    s_cmp_lt_u32 s3, 4
    s_cbranch_scc1 KF_COMPUTE
    s_cmp_eq_u32 s3, 6
    s_cbranch_scc1 KF_AUX
    s_cmp_eq_u32 s3, 5
    s_cbranch_scc1 KF_BL
    v_lshrrev_b32 v3, 3, v2
    v_and_b32 v4, 4, v3
    v_and_b32 v3, 3, v3
    v_lshl_or_b32 v3, v4, 1, v3
    v_mul_u32_u24 v3, 896, v3
    v_and_b32 v4, 7, v2
    v_lshrrev_b32 v5, 4, v2
    v_xor_b32 v4, v4, v5
    v_lshlrev_b32 v4, 4, v4
    v_add_u32 v5, v3, v4
    v_xor_b32 v4, 64, v4
    v_add_u32 v6, v3, v4
    v_add_u32 v16, 0, v5
    v_add_u32 v17, 13312, v6
    v_add_u32 v18, 1536, v5
    v_add_u32 v19, 14848, v6
    v_add_u32 v20, 28672, v5
    v_add_u32 v21, 41984, v6
    v_add_u32 v22, 30208, v5
    v_add_u32 v23, 43520, v6
    s_mul_i32 s61, s56, 114688
    s_add_u32 s62, s61, 57344
    s_waitcnt lgkmcnt(0)
    s_mov_b32 s40, s4
    s_and_b32 s41, s5, 0xffff
    s_mov_b32 s42, 1835008
    s_mov_b32 s43, 0x20000
    s_add_u32 s68, s61, 0
    s_mov_b32 m0, 0
    s_nop 0
    buffer_load_dwordx4 v16, s[40:43], s68 offen offset:0 lds
    buffer_load_dwordx4 v17, s[40:43], s68 offen offset:1024 lds
    buffer_load_dwordx4 v18, s[40:43], s68 offen offset:2048 lds
    buffer_load_dwordx4 v19, s[40:43], s68 offen offset:3072 lds
    s_mov_b32 m0, 4096
    s_nop 0
    buffer_load_dwordx4 v20, s[40:43], s68 offen offset:0 lds
    buffer_load_dwordx4 v21, s[40:43], s68 offen offset:1024 lds
    buffer_load_dwordx4 v22, s[40:43], s68 offen offset:2048 lds
    buffer_load_dwordx4 v23, s[40:43], s68 offen offset:3072 lds
    s_add_u32 s68, s62, 0
    s_mov_b32 m0, 8192
    s_nop 0
    buffer_load_dwordx4 v16, s[40:43], s68 offen offset:0 lds
    buffer_load_dwordx4 v17, s[40:43], s68 offen offset:1024 lds
    buffer_load_dwordx4 v18, s[40:43], s68 offen offset:2048 lds
    buffer_load_dwordx4 v19, s[40:43], s68 offen offset:3072 lds
    s_mov_b32 m0, 12288
    s_nop 0
    buffer_load_dwordx4 v20, s[40:43], s68 offen offset:0 lds
    buffer_load_dwordx4 v21, s[40:43], s68 offen offset:1024 lds
    buffer_load_dwordx4 v22, s[40:43], s68 offen offset:2048 lds
    buffer_load_dwordx4 v23, s[40:43], s68 offen offset:3072 lds
    s_add_u32 s68, s61, 128
    s_mov_b32 m0, 30720
    s_nop 0
    buffer_load_dwordx4 v16, s[40:43], s68 offen offset:0 lds
    buffer_load_dwordx4 v17, s[40:43], s68 offen offset:1024 lds
    buffer_load_dwordx4 v18, s[40:43], s68 offen offset:2048 lds
    buffer_load_dwordx4 v19, s[40:43], s68 offen offset:3072 lds
    s_mov_b32 m0, 34816
    s_nop 0
    buffer_load_dwordx4 v20, s[40:43], s68 offen offset:0 lds
    buffer_load_dwordx4 v21, s[40:43], s68 offen offset:1024 lds
    buffer_load_dwordx4 v22, s[40:43], s68 offen offset:2048 lds
    buffer_load_dwordx4 v23, s[40:43], s68 offen offset:3072 lds
    s_add_u32 s68, s62, 128
    s_mov_b32 m0, 38912
    s_nop 0
    buffer_load_dwordx4 v16, s[40:43], s68 offen offset:0 lds
    buffer_load_dwordx4 v17, s[40:43], s68 offen offset:1024 lds
    buffer_load_dwordx4 v18, s[40:43], s68 offen offset:2048 lds
    buffer_load_dwordx4 v19, s[40:43], s68 offen offset:3072 lds
    s_mov_b32 m0, 43008
    s_nop 0
    buffer_load_dwordx4 v20, s[40:43], s68 offen offset:0 lds
    buffer_load_dwordx4 v21, s[40:43], s68 offen offset:1024 lds
    buffer_load_dwordx4 v22, s[40:43], s68 offen offset:2048 lds
    buffer_load_dwordx4 v23, s[40:43], s68 offen offset:3072 lds
    s_add_u32 s68, s61, 256
    s_mov_b32 m0, 61440
    s_nop 0
    buffer_load_dwordx4 v16, s[40:43], s68 offen offset:0 lds
    buffer_load_dwordx4 v17, s[40:43], s68 offen offset:1024 lds
    buffer_load_dwordx4 v18, s[40:43], s68 offen offset:2048 lds
    buffer_load_dwordx4 v19, s[40:43], s68 offen offset:3072 lds
    s_mov_b32 m0, 65536
    s_nop 0
    buffer_load_dwordx4 v20, s[40:43], s68 offen offset:0 lds
    buffer_load_dwordx4 v21, s[40:43], s68 offen offset:1024 lds
    buffer_load_dwordx4 v22, s[40:43], s68 offen offset:2048 lds
    buffer_load_dwordx4 v23, s[40:43], s68 offen offset:3072 lds
    s_add_u32 s68, s62, 256
    s_mov_b32 m0, 69632
    s_nop 0
    buffer_load_dwordx4 v16, s[40:43], s68 offen offset:0 lds
    buffer_load_dwordx4 v17, s[40:43], s68 offen offset:1024 lds
    buffer_load_dwordx4 v18, s[40:43], s68 offen offset:2048 lds
    buffer_load_dwordx4 v19, s[40:43], s68 offen offset:3072 lds
    s_mov_b32 m0, 73728
    s_nop 0
    buffer_load_dwordx4 v20, s[40:43], s68 offen offset:0 lds
    buffer_load_dwordx4 v21, s[40:43], s68 offen offset:1024 lds
    buffer_load_dwordx4 v22, s[40:43], s68 offen offset:2048 lds
    buffer_load_dwordx4 v23, s[40:43], s68 offen offset:3072 lds
    s_add_u32 s68, s61, 384
    s_mov_b32 m0, 92160
    s_nop 0
    buffer_load_dwordx4 v16, s[40:43], s68 offen offset:0 lds
    buffer_load_dwordx4 v17, s[40:43], s68 offen offset:1024 lds
    buffer_load_dwordx4 v18, s[40:43], s68 offen offset:2048 lds
    buffer_load_dwordx4 v19, s[40:43], s68 offen offset:3072 lds
    s_mov_b32 m0, 96256
    s_nop 0
    buffer_load_dwordx4 v20, s[40:43], s68 offen offset:0 lds
    buffer_load_dwordx4 v21, s[40:43], s68 offen offset:1024 lds
    buffer_load_dwordx4 v22, s[40:43], s68 offen offset:2048 lds
    buffer_load_dwordx4 v23, s[40:43], s68 offen offset:3072 lds
    s_add_u32 s68, s62, 384
    s_mov_b32 m0, 100352
    s_nop 0
    buffer_load_dwordx4 v16, s[40:43], s68 offen offset:0 lds
    buffer_load_dwordx4 v17, s[40:43], s68 offen offset:1024 lds
    buffer_load_dwordx4 v18, s[40:43], s68 offen offset:2048 lds
    buffer_load_dwordx4 v19, s[40:43], s68 offen offset:3072 lds
    s_mov_b32 m0, 104448
    s_nop 0
    buffer_load_dwordx4 v20, s[40:43], s68 offen offset:0 lds
    buffer_load_dwordx4 v21, s[40:43], s68 offen offset:1024 lds
    buffer_load_dwordx4 v22, s[40:43], s68 offen offset:2048 lds
    buffer_load_dwordx4 v23, s[40:43], s68 offen offset:3072 lds
    s_mov_b32 s32, s30
    s_and_b32 s33, s31, 0xffff
    s_mov_b32 s34, 23068672
    s_mov_b32 s35, 0x20000
    s_mov_b32 s36, s28
    s_and_b32 s37, s29, 0xffff
    s_mov_b32 s38, 256
    s_mov_b32 s39, 0x20000
    v_lshrrev_b32 v3, 3, v2
    v_and_b32 v4, 4, v3
    v_and_b32 v3, 3, v3
    v_lshl_or_b32 v3, v4, 1, v3
    v_mul_u32_u24 v3, 4096, v3
    v_and_b32 v4, 7, v2
    v_lshrrev_b32 v7, 4, v2
    v_xor_b32 v4, v4, v7
    v_lshlrev_b32 v4, 4, v4
    v_add_u32 v7, v3, v4
    v_xor_b32 v4, 64, v4
    v_add_u32 v8, v3, v4
    v_add_u32 v24, 0, v7
    v_add_u32 v25, 64512, v8
    v_add_u32 v26, 14336, v7
    v_add_u32 v27, 78848, v8
    v_add_u32 v28, 131072, v7
    v_add_u32 v29, 195584, v8
    v_add_u32 v30, 145408, v7
    v_add_u32 v31, 209920, v8
    s_lshl_b32 s66, s99, 7
    s_lshl_b32 s64, s56, 19
    s_add_u32 s65, s64, 262144
    s_cmp_lt_u32 s58, 6
    s_cselect_b32 s60, s6, s8
    s_cselect_b32 s63, s7, s9
    s_cmp_lt_u32 s58, 4
    s_cselect_b32 s44, s18, s60
    s_cselect_b32 s63, s19, s63
    s_and_b32 s45, s63, 0xffff
    s_mov_b32 s46, 8388608
    s_mov_b32 s47, 0x20000
    s_waitcnt vmcnt(48)
    s_barrier
    s_add_u32 s68, s61, 512
    s_mov_b32 m0, 122880
    s_nop 0
    buffer_load_dwordx4 v16, s[40:43], s68 offen offset:0 lds
    buffer_load_dwordx4 v17, s[40:43], s68 offen offset:1024 lds
    buffer_load_dwordx4 v18, s[40:43], s68 offen offset:2048 lds
    buffer_load_dwordx4 v19, s[40:43], s68 offen offset:3072 lds
    s_mov_b32 m0, 126976
    s_nop 0
    buffer_load_dwordx4 v20, s[40:43], s68 offen offset:0 lds
    buffer_load_dwordx4 v21, s[40:43], s68 offen offset:1024 lds
    buffer_load_dwordx4 v22, s[40:43], s68 offen offset:2048 lds
    buffer_load_dwordx4 v23, s[40:43], s68 offen offset:3072 lds
    s_add_u32 s68, s62, 512
    s_mov_b32 m0, 131072
    s_nop 0
    buffer_load_dwordx4 v16, s[40:43], s68 offen offset:0 lds
    buffer_load_dwordx4 v17, s[40:43], s68 offen offset:1024 lds
    buffer_load_dwordx4 v18, s[40:43], s68 offen offset:2048 lds
    buffer_load_dwordx4 v19, s[40:43], s68 offen offset:3072 lds
    s_mov_b32 m0, 135168
    s_nop 0
    buffer_load_dwordx4 v20, s[40:43], s68 offen offset:0 lds
    buffer_load_dwordx4 v21, s[40:43], s68 offen offset:1024 lds
    buffer_load_dwordx4 v22, s[40:43], s68 offen offset:2048 lds
    buffer_load_dwordx4 v23, s[40:43], s68 offen offset:3072 lds
    s_waitcnt vmcnt(48)
    s_barrier
    s_add_u32 s68, s61, 640
    s_mov_b32 m0, 0
    s_nop 0
    buffer_load_dwordx4 v16, s[40:43], s68 offen offset:0 lds
    buffer_load_dwordx4 v17, s[40:43], s68 offen offset:1024 lds
    buffer_load_dwordx4 v18, s[40:43], s68 offen offset:2048 lds
    buffer_load_dwordx4 v19, s[40:43], s68 offen offset:3072 lds
    s_mov_b32 m0, 4096
    s_nop 0
    buffer_load_dwordx4 v20, s[40:43], s68 offen offset:0 lds
    buffer_load_dwordx4 v21, s[40:43], s68 offen offset:1024 lds
    buffer_load_dwordx4 v22, s[40:43], s68 offen offset:2048 lds
    buffer_load_dwordx4 v23, s[40:43], s68 offen offset:3072 lds
    s_add_u32 s68, s62, 640
    s_mov_b32 m0, 8192
    s_nop 0
    buffer_load_dwordx4 v16, s[40:43], s68 offen offset:0 lds
    buffer_load_dwordx4 v17, s[40:43], s68 offen offset:1024 lds
    buffer_load_dwordx4 v18, s[40:43], s68 offen offset:2048 lds
    buffer_load_dwordx4 v19, s[40:43], s68 offen offset:3072 lds
    s_mov_b32 m0, 12288
    s_nop 0
    buffer_load_dwordx4 v20, s[40:43], s68 offen offset:0 lds
    buffer_load_dwordx4 v21, s[40:43], s68 offen offset:1024 lds
    buffer_load_dwordx4 v22, s[40:43], s68 offen offset:2048 lds
    buffer_load_dwordx4 v23, s[40:43], s68 offen offset:3072 lds
    s_waitcnt vmcnt(48)
    s_barrier
    s_add_u32 s68, s61, 768
    s_mov_b32 m0, 30720
    s_nop 0
    buffer_load_dwordx4 v16, s[40:43], s68 offen offset:0 lds
    buffer_load_dwordx4 v17, s[40:43], s68 offen offset:1024 lds
    buffer_load_dwordx4 v18, s[40:43], s68 offen offset:2048 lds
    buffer_load_dwordx4 v19, s[40:43], s68 offen offset:3072 lds
    s_mov_b32 m0, 34816
    s_nop 0
    buffer_load_dwordx4 v20, s[40:43], s68 offen offset:0 lds
    buffer_load_dwordx4 v21, s[40:43], s68 offen offset:1024 lds
    buffer_load_dwordx4 v22, s[40:43], s68 offen offset:2048 lds
    buffer_load_dwordx4 v23, s[40:43], s68 offen offset:3072 lds
    s_add_u32 s68, s62, 768
    s_mov_b32 m0, 38912
    s_nop 0
    buffer_load_dwordx4 v16, s[40:43], s68 offen offset:0 lds
    buffer_load_dwordx4 v17, s[40:43], s68 offen offset:1024 lds
    buffer_load_dwordx4 v18, s[40:43], s68 offen offset:2048 lds
    buffer_load_dwordx4 v19, s[40:43], s68 offen offset:3072 lds
    s_mov_b32 m0, 43008
    s_nop 0
    buffer_load_dwordx4 v20, s[40:43], s68 offen offset:0 lds
    buffer_load_dwordx4 v21, s[40:43], s68 offen offset:1024 lds
    buffer_load_dwordx4 v22, s[40:43], s68 offen offset:2048 lds
    buffer_load_dwordx4 v23, s[40:43], s68 offen offset:3072 lds
    s_cmp_lt_u32 s58, 4
    s_cbranch_scc0 AL_Y
    s_waitcnt vmcnt(48)
    s_barrier
    s_add_u32 s68, s61, 0
    s_mov_b32 m0, 61440
    s_nop 0
    buffer_load_dwordx4 v16, s[40:43], s68 offen offset:0 lds
    buffer_load_dwordx4 v17, s[40:43], s68 offen offset:1024 lds
    buffer_load_dwordx4 v18, s[40:43], s68 offen offset:2048 lds
    buffer_load_dwordx4 v19, s[40:43], s68 offen offset:3072 lds
    s_mov_b32 m0, 65536
    s_nop 0
    buffer_load_dwordx4 v20, s[40:43], s68 offen offset:0 lds
    buffer_load_dwordx4 v21, s[40:43], s68 offen offset:1024 lds
    buffer_load_dwordx4 v22, s[40:43], s68 offen offset:2048 lds
    buffer_load_dwordx4 v23, s[40:43], s68 offen offset:3072 lds
    s_add_u32 s68, s62, 0
    s_mov_b32 m0, 69632
    s_nop 0
    buffer_load_dwordx4 v16, s[40:43], s68 offen offset:0 lds
    buffer_load_dwordx4 v17, s[40:43], s68 offen offset:1024 lds
    buffer_load_dwordx4 v18, s[40:43], s68 offen offset:2048 lds
    buffer_load_dwordx4 v19, s[40:43], s68 offen offset:3072 lds
    s_mov_b32 m0, 73728
    s_nop 0
    buffer_load_dwordx4 v20, s[40:43], s68 offen offset:0 lds
    buffer_load_dwordx4 v21, s[40:43], s68 offen offset:1024 lds
    buffer_load_dwordx4 v22, s[40:43], s68 offen offset:2048 lds
    buffer_load_dwordx4 v23, s[40:43], s68 offen offset:3072 lds
    s_waitcnt vmcnt(48)
    s_barrier
    s_add_u32 s68, s61, 128
    s_mov_b32 m0, 92160
    s_nop 0
    buffer_load_dwordx4 v16, s[40:43], s68 offen offset:0 lds
    buffer_load_dwordx4 v17, s[40:43], s68 offen offset:1024 lds
    buffer_load_dwordx4 v18, s[40:43], s68 offen offset:2048 lds
    buffer_load_dwordx4 v19, s[40:43], s68 offen offset:3072 lds
    s_mov_b32 m0, 96256
    s_nop 0
    buffer_load_dwordx4 v20, s[40:43], s68 offen offset:0 lds
    buffer_load_dwordx4 v21, s[40:43], s68 offen offset:1024 lds
    buffer_load_dwordx4 v22, s[40:43], s68 offen offset:2048 lds
    buffer_load_dwordx4 v23, s[40:43], s68 offen offset:3072 lds
    s_add_u32 s68, s62, 128
    s_mov_b32 m0, 100352
    s_nop 0
    buffer_load_dwordx4 v16, s[40:43], s68 offen offset:0 lds
    buffer_load_dwordx4 v17, s[40:43], s68 offen offset:1024 lds
    buffer_load_dwordx4 v18, s[40:43], s68 offen offset:2048 lds
    buffer_load_dwordx4 v19, s[40:43], s68 offen offset:3072 lds
    s_mov_b32 m0, 104448
    s_nop 0
    buffer_load_dwordx4 v20, s[40:43], s68 offen offset:0 lds
    buffer_load_dwordx4 v21, s[40:43], s68 offen offset:1024 lds
    buffer_load_dwordx4 v22, s[40:43], s68 offen offset:2048 lds
    buffer_load_dwordx4 v23, s[40:43], s68 offen offset:3072 lds
    s_waitcnt vmcnt(48)
    s_barrier
    s_add_u32 s68, s61, 256
    s_mov_b32 m0, 122880
    s_nop 0
    buffer_load_dwordx4 v16, s[40:43], s68 offen offset:0 lds
    buffer_load_dwordx4 v17, s[40:43], s68 offen offset:1024 lds
    buffer_load_dwordx4 v18, s[40:43], s68 offen offset:2048 lds
    buffer_load_dwordx4 v19, s[40:43], s68 offen offset:3072 lds
    s_mov_b32 m0, 126976
    s_nop 0
    buffer_load_dwordx4 v20, s[40:43], s68 offen offset:0 lds
    buffer_load_dwordx4 v21, s[40:43], s68 offen offset:1024 lds
    buffer_load_dwordx4 v22, s[40:43], s68 offen offset:2048 lds
    buffer_load_dwordx4 v23, s[40:43], s68 offen offset:3072 lds
    s_add_u32 s68, s62, 256
    s_mov_b32 m0, 131072
    s_nop 0
    buffer_load_dwordx4 v16, s[40:43], s68 offen offset:0 lds
    buffer_load_dwordx4 v17, s[40:43], s68 offen offset:1024 lds
    buffer_load_dwordx4 v18, s[40:43], s68 offen offset:2048 lds
    buffer_load_dwordx4 v19, s[40:43], s68 offen offset:3072 lds
    s_mov_b32 m0, 135168
    s_nop 0
    buffer_load_dwordx4 v20, s[40:43], s68 offen offset:0 lds
    buffer_load_dwordx4 v21, s[40:43], s68 offen offset:1024 lds
    buffer_load_dwordx4 v22, s[40:43], s68 offen offset:2048 lds
    buffer_load_dwordx4 v23, s[40:43], s68 offen offset:3072 lds
    s_waitcnt vmcnt(48)
    s_barrier
    s_add_u32 s68, s61, 384
    s_mov_b32 m0, 0
    s_nop 0
    buffer_load_dwordx4 v16, s[40:43], s68 offen offset:0 lds
    buffer_load_dwordx4 v17, s[40:43], s68 offen offset:1024 lds
    buffer_load_dwordx4 v18, s[40:43], s68 offen offset:2048 lds
    buffer_load_dwordx4 v19, s[40:43], s68 offen offset:3072 lds
    s_mov_b32 m0, 4096
    s_nop 0
    buffer_load_dwordx4 v20, s[40:43], s68 offen offset:0 lds
    buffer_load_dwordx4 v21, s[40:43], s68 offen offset:1024 lds
    buffer_load_dwordx4 v22, s[40:43], s68 offen offset:2048 lds
    buffer_load_dwordx4 v23, s[40:43], s68 offen offset:3072 lds
    s_add_u32 s68, s62, 384
    s_mov_b32 m0, 8192
    s_nop 0
    buffer_load_dwordx4 v16, s[40:43], s68 offen offset:0 lds
    buffer_load_dwordx4 v17, s[40:43], s68 offen offset:1024 lds
    buffer_load_dwordx4 v18, s[40:43], s68 offen offset:2048 lds
    buffer_load_dwordx4 v19, s[40:43], s68 offen offset:3072 lds
    s_mov_b32 m0, 12288
    s_nop 0
    buffer_load_dwordx4 v20, s[40:43], s68 offen offset:0 lds
    buffer_load_dwordx4 v21, s[40:43], s68 offen offset:1024 lds
    buffer_load_dwordx4 v22, s[40:43], s68 offen offset:2048 lds
    buffer_load_dwordx4 v23, s[40:43], s68 offen offset:3072 lds
    s_waitcnt vmcnt(48)
    s_barrier
    s_add_u32 s68, s61, 512
    s_mov_b32 m0, 30720
    s_nop 0
    buffer_load_dwordx4 v16, s[40:43], s68 offen offset:0 lds
    buffer_load_dwordx4 v17, s[40:43], s68 offen offset:1024 lds
    buffer_load_dwordx4 v18, s[40:43], s68 offen offset:2048 lds
    buffer_load_dwordx4 v19, s[40:43], s68 offen offset:3072 lds
    s_mov_b32 m0, 34816
    s_nop 0
    buffer_load_dwordx4 v20, s[40:43], s68 offen offset:0 lds
    buffer_load_dwordx4 v21, s[40:43], s68 offen offset:1024 lds
    buffer_load_dwordx4 v22, s[40:43], s68 offen offset:2048 lds
    buffer_load_dwordx4 v23, s[40:43], s68 offen offset:3072 lds
    s_add_u32 s68, s62, 512
    s_mov_b32 m0, 38912
    s_nop 0
    buffer_load_dwordx4 v16, s[40:43], s68 offen offset:0 lds
    buffer_load_dwordx4 v17, s[40:43], s68 offen offset:1024 lds
    buffer_load_dwordx4 v18, s[40:43], s68 offen offset:2048 lds
    buffer_load_dwordx4 v19, s[40:43], s68 offen offset:3072 lds
    s_mov_b32 m0, 43008
    s_nop 0
    buffer_load_dwordx4 v20, s[40:43], s68 offen offset:0 lds
    buffer_load_dwordx4 v21, s[40:43], s68 offen offset:1024 lds
    buffer_load_dwordx4 v22, s[40:43], s68 offen offset:2048 lds
    buffer_load_dwordx4 v23, s[40:43], s68 offen offset:3072 lds
    s_waitcnt vmcnt(48)
    s_barrier
    s_add_u32 s68, s61, 640
    s_mov_b32 m0, 61440
    s_nop 0
    buffer_load_dwordx4 v16, s[40:43], s68 offen offset:0 lds
    buffer_load_dwordx4 v17, s[40:43], s68 offen offset:1024 lds
    buffer_load_dwordx4 v18, s[40:43], s68 offen offset:2048 lds
    buffer_load_dwordx4 v19, s[40:43], s68 offen offset:3072 lds
    s_mov_b32 m0, 65536
    s_nop 0
    buffer_load_dwordx4 v20, s[40:43], s68 offen offset:0 lds
    buffer_load_dwordx4 v21, s[40:43], s68 offen offset:1024 lds
    buffer_load_dwordx4 v22, s[40:43], s68 offen offset:2048 lds
    buffer_load_dwordx4 v23, s[40:43], s68 offen offset:3072 lds
    s_add_u32 s68, s62, 640
    s_mov_b32 m0, 69632
    s_nop 0
    buffer_load_dwordx4 v16, s[40:43], s68 offen offset:0 lds
    buffer_load_dwordx4 v17, s[40:43], s68 offen offset:1024 lds
    buffer_load_dwordx4 v18, s[40:43], s68 offen offset:2048 lds
    buffer_load_dwordx4 v19, s[40:43], s68 offen offset:3072 lds
    s_mov_b32 m0, 73728
    s_nop 0
    buffer_load_dwordx4 v20, s[40:43], s68 offen offset:0 lds
    buffer_load_dwordx4 v21, s[40:43], s68 offen offset:1024 lds
    buffer_load_dwordx4 v22, s[40:43], s68 offen offset:2048 lds
    buffer_load_dwordx4 v23, s[40:43], s68 offen offset:3072 lds
    s_waitcnt vmcnt(48)
    s_barrier
    s_add_u32 s68, s61, 768
    s_mov_b32 m0, 92160
    s_nop 0
    buffer_load_dwordx4 v16, s[40:43], s68 offen offset:0 lds
    buffer_load_dwordx4 v17, s[40:43], s68 offen offset:1024 lds
    buffer_load_dwordx4 v18, s[40:43], s68 offen offset:2048 lds
    buffer_load_dwordx4 v19, s[40:43], s68 offen offset:3072 lds
    s_mov_b32 m0, 96256
    s_nop 0
    buffer_load_dwordx4 v20, s[40:43], s68 offen offset:0 lds
    buffer_load_dwordx4 v21, s[40:43], s68 offen offset:1024 lds
    buffer_load_dwordx4 v22, s[40:43], s68 offen offset:2048 lds
    buffer_load_dwordx4 v23, s[40:43], s68 offen offset:3072 lds
    s_add_u32 s68, s62, 768
    s_mov_b32 m0, 100352
    s_nop 0
    buffer_load_dwordx4 v16, s[40:43], s68 offen offset:0 lds
    buffer_load_dwordx4 v17, s[40:43], s68 offen offset:1024 lds
    buffer_load_dwordx4 v18, s[40:43], s68 offen offset:2048 lds
    buffer_load_dwordx4 v19, s[40:43], s68 offen offset:3072 lds
    s_mov_b32 m0, 104448
    s_nop 0
    buffer_load_dwordx4 v20, s[40:43], s68 offen offset:0 lds
    buffer_load_dwordx4 v21, s[40:43], s68 offen offset:1024 lds
    buffer_load_dwordx4 v22, s[40:43], s68 offen offset:2048 lds
    buffer_load_dwordx4 v23, s[40:43], s68 offen offset:3072 lds
    s_waitcnt vmcnt(48)
    s_barrier
    s_add_u32 s68, s64, s66
    s_mov_b32 m0, 122880
    s_nop 0
    buffer_load_dwordx4 v24, s[44:47], s68 offen offset:0 lds
    buffer_load_dwordx4 v25, s[44:47], s68 offen offset:1024 lds
    buffer_load_dwordx4 v26, s[44:47], s68 offen offset:2048 lds
    buffer_load_dwordx4 v27, s[44:47], s68 offen offset:3072 lds
    s_mov_b32 m0, 126976
    s_nop 0
    buffer_load_dwordx4 v28, s[44:47], s68 offen offset:0 lds
    buffer_load_dwordx4 v29, s[44:47], s68 offen offset:1024 lds
    buffer_load_dwordx4 v30, s[44:47], s68 offen offset:2048 lds
    buffer_load_dwordx4 v31, s[44:47], s68 offen offset:3072 lds
    s_add_u32 s68, s65, s66
    s_add_u32 s66, s66, 128
    s_and_b32 s66, s66, 4095
    s_mov_b32 m0, 131072
    s_nop 0
    buffer_load_dwordx4 v24, s[44:47], s68 offen offset:0 lds
    buffer_load_dwordx4 v25, s[44:47], s68 offen offset:1024 lds
    buffer_load_dwordx4 v26, s[44:47], s68 offen offset:2048 lds
    buffer_load_dwordx4 v27, s[44:47], s68 offen offset:3072 lds
    s_mov_b32 m0, 135168
    s_nop 0
    buffer_load_dwordx4 v28, s[44:47], s68 offen offset:0 lds
    buffer_load_dwordx4 v29, s[44:47], s68 offen offset:1024 lds
    buffer_load_dwordx4 v30, s[44:47], s68 offen offset:2048 lds
    buffer_load_dwordx4 v31, s[44:47], s68 offen offset:3072 lds
    s_waitcnt vmcnt(48)
    s_barrier
    s_add_u32 s68, s64, s66
    s_mov_b32 m0, 0
    s_nop 0
    buffer_load_dwordx4 v24, s[44:47], s68 offen offset:0 lds
    buffer_load_dwordx4 v25, s[44:47], s68 offen offset:1024 lds
    buffer_load_dwordx4 v26, s[44:47], s68 offen offset:2048 lds
    buffer_load_dwordx4 v27, s[44:47], s68 offen offset:3072 lds
    s_mov_b32 m0, 4096
    s_nop 0
    buffer_load_dwordx4 v28, s[44:47], s68 offen offset:0 lds
    buffer_load_dwordx4 v29, s[44:47], s68 offen offset:1024 lds
    buffer_load_dwordx4 v30, s[44:47], s68 offen offset:2048 lds
    buffer_load_dwordx4 v31, s[44:47], s68 offen offset:3072 lds
    s_add_u32 s68, s65, s66
    s_add_u32 s66, s66, 128
    s_and_b32 s66, s66, 4095
    s_mov_b32 m0, 8192
    s_nop 0
    buffer_load_dwordx4 v24, s[44:47], s68 offen offset:0 lds
    buffer_load_dwordx4 v25, s[44:47], s68 offen offset:1024 lds
    buffer_load_dwordx4 v26, s[44:47], s68 offen offset:2048 lds
    buffer_load_dwordx4 v27, s[44:47], s68 offen offset:3072 lds
    s_mov_b32 m0, 12288
    s_nop 0
    buffer_load_dwordx4 v28, s[44:47], s68 offen offset:0 lds
    buffer_load_dwordx4 v29, s[44:47], s68 offen offset:1024 lds
    buffer_load_dwordx4 v30, s[44:47], s68 offen offset:2048 lds
    buffer_load_dwordx4 v31, s[44:47], s68 offen offset:3072 lds
    s_waitcnt vmcnt(48)
    s_barrier
    s_add_u32 s68, s64, s66
    s_mov_b32 m0, 30720
    s_nop 0
    buffer_load_dwordx4 v24, s[44:47], s68 offen offset:0 lds
    buffer_load_dwordx4 v25, s[44:47], s68 offen offset:1024 lds
    buffer_load_dwordx4 v26, s[44:47], s68 offen offset:2048 lds
    buffer_load_dwordx4 v27, s[44:47], s68 offen offset:3072 lds
    s_mov_b32 m0, 34816
    s_nop 0
    buffer_load_dwordx4 v28, s[44:47], s68 offen offset:0 lds
    buffer_load_dwordx4 v29, s[44:47], s68 offen offset:1024 lds
    buffer_load_dwordx4 v30, s[44:47], s68 offen offset:2048 lds
    buffer_load_dwordx4 v31, s[44:47], s68 offen offset:3072 lds
    s_add_u32 s68, s65, s66
    s_add_u32 s66, s66, 128
    s_and_b32 s66, s66, 4095
    s_mov_b32 m0, 38912
    s_nop 0
    buffer_load_dwordx4 v24, s[44:47], s68 offen offset:0 lds
    buffer_load_dwordx4 v25, s[44:47], s68 offen offset:1024 lds
    buffer_load_dwordx4 v26, s[44:47], s68 offen offset:2048 lds
    buffer_load_dwordx4 v27, s[44:47], s68 offen offset:3072 lds
    s_mov_b32 m0, 43008
    s_nop 0
    buffer_load_dwordx4 v28, s[44:47], s68 offen offset:0 lds
    buffer_load_dwordx4 v29, s[44:47], s68 offen offset:1024 lds
    buffer_load_dwordx4 v30, s[44:47], s68 offen offset:2048 lds
    buffer_load_dwordx4 v31, s[44:47], s68 offen offset:3072 lds
    s_waitcnt vmcnt(48)
    s_barrier
    s_add_u32 s68, s64, s66
    s_mov_b32 m0, 61440
    s_nop 0
    buffer_load_dwordx4 v24, s[44:47], s68 offen offset:0 lds
    buffer_load_dwordx4 v25, s[44:47], s68 offen offset:1024 lds
    buffer_load_dwordx4 v26, s[44:47], s68 offen offset:2048 lds
    buffer_load_dwordx4 v27, s[44:47], s68 offen offset:3072 lds
    s_mov_b32 m0, 65536
    s_nop 0
    buffer_load_dwordx4 v28, s[44:47], s68 offen offset:0 lds
    buffer_load_dwordx4 v29, s[44:47], s68 offen offset:1024 lds
    buffer_load_dwordx4 v30, s[44:47], s68 offen offset:2048 lds
    buffer_load_dwordx4 v31, s[44:47], s68 offen offset:3072 lds
    s_add_u32 s68, s65, s66
    s_add_u32 s66, s66, 128
    s_and_b32 s66, s66, 4095
    s_mov_b32 m0, 69632
    s_nop 0
    buffer_load_dwordx4 v24, s[44:47], s68 offen offset:0 lds
    buffer_load_dwordx4 v25, s[44:47], s68 offen offset:1024 lds
    buffer_load_dwordx4 v26, s[44:47], s68 offen offset:2048 lds
    buffer_load_dwordx4 v27, s[44:47], s68 offen offset:3072 lds
    s_mov_b32 m0, 73728
    s_nop 0
    buffer_load_dwordx4 v28, s[44:47], s68 offen offset:0 lds
    buffer_load_dwordx4 v29, s[44:47], s68 offen offset:1024 lds
    buffer_load_dwordx4 v30, s[44:47], s68 offen offset:2048 lds
    buffer_load_dwordx4 v31, s[44:47], s68 offen offset:3072 lds
    s_barrier
    s_waitcnt vmcnt(48)
    s_add_u32 s68, s64, s66
    s_mov_b32 m0, 92160
    s_nop 0
    buffer_load_dwordx4 v24, s[44:47], s68 offen offset:0 lds
    buffer_load_dwordx4 v25, s[44:47], s68 offen offset:1024 lds
    buffer_load_dwordx4 v26, s[44:47], s68 offen offset:2048 lds
    buffer_load_dwordx4 v27, s[44:47], s68 offen offset:3072 lds
    s_mov_b32 m0, 96256
    s_nop 0
    buffer_load_dwordx4 v28, s[44:47], s68 offen offset:0 lds
    buffer_load_dwordx4 v29, s[44:47], s68 offen offset:1024 lds
    buffer_load_dwordx4 v30, s[44:47], s68 offen offset:2048 lds
    buffer_load_dwordx4 v31, s[44:47], s68 offen offset:3072 lds
    s_add_u32 s68, s65, s66
    s_add_u32 s66, s66, 128
    s_and_b32 s66, s66, 4095
    s_mov_b32 m0, 100352
    s_nop 0
    buffer_load_dwordx4 v24, s[44:47], s68 offen offset:0 lds
    buffer_load_dwordx4 v25, s[44:47], s68 offen offset:1024 lds
    buffer_load_dwordx4 v26, s[44:47], s68 offen offset:2048 lds
    buffer_load_dwordx4 v27, s[44:47], s68 offen offset:3072 lds
    s_mov_b32 m0, 104448
    s_nop 0
    buffer_load_dwordx4 v28, s[44:47], s68 offen offset:0 lds
    buffer_load_dwordx4 v29, s[44:47], s68 offen offset:1024 lds
    buffer_load_dwordx4 v30, s[44:47], s68 offen offset:2048 lds
    buffer_load_dwordx4 v31, s[44:47], s68 offen offset:3072 lds
    s_mov_b32 s70, 122880
    s_branch AL_M
AL_Y:
    s_waitcnt vmcnt(48)
    s_barrier
    s_add_u32 s68, s64, s66
    s_mov_b32 m0, 61440
    s_nop 0
    buffer_load_dwordx4 v24, s[44:47], s68 offen offset:0 lds
    buffer_load_dwordx4 v25, s[44:47], s68 offen offset:1024 lds
    buffer_load_dwordx4 v26, s[44:47], s68 offen offset:2048 lds
    buffer_load_dwordx4 v27, s[44:47], s68 offen offset:3072 lds
    s_mov_b32 m0, 65536
    s_nop 0
    buffer_load_dwordx4 v28, s[44:47], s68 offen offset:0 lds
    buffer_load_dwordx4 v29, s[44:47], s68 offen offset:1024 lds
    buffer_load_dwordx4 v30, s[44:47], s68 offen offset:2048 lds
    buffer_load_dwordx4 v31, s[44:47], s68 offen offset:3072 lds
    s_add_u32 s68, s65, s66
    s_add_u32 s66, s66, 128
    s_and_b32 s66, s66, 4095
    s_mov_b32 m0, 69632
    s_nop 0
    buffer_load_dwordx4 v24, s[44:47], s68 offen offset:0 lds
    buffer_load_dwordx4 v25, s[44:47], s68 offen offset:1024 lds
    buffer_load_dwordx4 v26, s[44:47], s68 offen offset:2048 lds
    buffer_load_dwordx4 v27, s[44:47], s68 offen offset:3072 lds
    s_mov_b32 m0, 73728
    s_nop 0
    buffer_load_dwordx4 v28, s[44:47], s68 offen offset:0 lds
    buffer_load_dwordx4 v29, s[44:47], s68 offen offset:1024 lds
    buffer_load_dwordx4 v30, s[44:47], s68 offen offset:2048 lds
    buffer_load_dwordx4 v31, s[44:47], s68 offen offset:3072 lds
    s_waitcnt vmcnt(48)
    s_barrier
    s_add_u32 s68, s64, s66
    s_mov_b32 m0, 92160
    s_nop 0
    buffer_load_dwordx4 v24, s[44:47], s68 offen offset:0 lds
    buffer_load_dwordx4 v25, s[44:47], s68 offen offset:1024 lds
    buffer_load_dwordx4 v26, s[44:47], s68 offen offset:2048 lds
    buffer_load_dwordx4 v27, s[44:47], s68 offen offset:3072 lds
    s_mov_b32 m0, 96256
    s_nop 0
    buffer_load_dwordx4 v28, s[44:47], s68 offen offset:0 lds
    buffer_load_dwordx4 v29, s[44:47], s68 offen offset:1024 lds
    buffer_load_dwordx4 v30, s[44:47], s68 offen offset:2048 lds
    buffer_load_dwordx4 v31, s[44:47], s68 offen offset:3072 lds
    s_add_u32 s68, s65, s66
    s_add_u32 s66, s66, 128
    s_and_b32 s66, s66, 4095
    s_mov_b32 m0, 100352
    s_nop 0
    buffer_load_dwordx4 v24, s[44:47], s68 offen offset:0 lds
    buffer_load_dwordx4 v25, s[44:47], s68 offen offset:1024 lds
    buffer_load_dwordx4 v26, s[44:47], s68 offen offset:2048 lds
    buffer_load_dwordx4 v27, s[44:47], s68 offen offset:3072 lds
    s_mov_b32 m0, 104448
    s_nop 0
    buffer_load_dwordx4 v28, s[44:47], s68 offen offset:0 lds
    buffer_load_dwordx4 v29, s[44:47], s68 offen offset:1024 lds
    buffer_load_dwordx4 v30, s[44:47], s68 offen offset:2048 lds
    buffer_load_dwordx4 v31, s[44:47], s68 offen offset:3072 lds
    s_waitcnt vmcnt(48)
    s_barrier
    s_add_u32 s68, s64, s66
    s_mov_b32 m0, 122880
    s_nop 0
    buffer_load_dwordx4 v24, s[44:47], s68 offen offset:0 lds
    buffer_load_dwordx4 v25, s[44:47], s68 offen offset:1024 lds
    buffer_load_dwordx4 v26, s[44:47], s68 offen offset:2048 lds
    buffer_load_dwordx4 v27, s[44:47], s68 offen offset:3072 lds
    s_mov_b32 m0, 126976
    s_nop 0
    buffer_load_dwordx4 v28, s[44:47], s68 offen offset:0 lds
    buffer_load_dwordx4 v29, s[44:47], s68 offen offset:1024 lds
    buffer_load_dwordx4 v30, s[44:47], s68 offen offset:2048 lds
    buffer_load_dwordx4 v31, s[44:47], s68 offen offset:3072 lds
    s_add_u32 s68, s65, s66
    s_add_u32 s66, s66, 128
    s_and_b32 s66, s66, 4095
    s_mov_b32 m0, 131072
    s_nop 0
    buffer_load_dwordx4 v24, s[44:47], s68 offen offset:0 lds
    buffer_load_dwordx4 v25, s[44:47], s68 offen offset:1024 lds
    buffer_load_dwordx4 v26, s[44:47], s68 offen offset:2048 lds
    buffer_load_dwordx4 v27, s[44:47], s68 offen offset:3072 lds
    s_mov_b32 m0, 135168
    s_nop 0
    buffer_load_dwordx4 v28, s[44:47], s68 offen offset:0 lds
    buffer_load_dwordx4 v29, s[44:47], s68 offen offset:1024 lds
    buffer_load_dwordx4 v30, s[44:47], s68 offen offset:2048 lds
    buffer_load_dwordx4 v31, s[44:47], s68 offen offset:3072 lds
    s_waitcnt vmcnt(48)
    s_barrier
    s_add_u32 s68, s64, s66
    s_mov_b32 m0, 0
    s_nop 0
    buffer_load_dwordx4 v24, s[44:47], s68 offen offset:0 lds
    buffer_load_dwordx4 v25, s[44:47], s68 offen offset:1024 lds
    buffer_load_dwordx4 v26, s[44:47], s68 offen offset:2048 lds
    buffer_load_dwordx4 v27, s[44:47], s68 offen offset:3072 lds
    s_mov_b32 m0, 4096
    s_nop 0
    buffer_load_dwordx4 v28, s[44:47], s68 offen offset:0 lds
    buffer_load_dwordx4 v29, s[44:47], s68 offen offset:1024 lds
    buffer_load_dwordx4 v30, s[44:47], s68 offen offset:2048 lds
    buffer_load_dwordx4 v31, s[44:47], s68 offen offset:3072 lds
    s_add_u32 s68, s65, s66
    s_add_u32 s66, s66, 128
    s_and_b32 s66, s66, 4095
    s_mov_b32 m0, 8192
    s_nop 0
    buffer_load_dwordx4 v24, s[44:47], s68 offen offset:0 lds
    buffer_load_dwordx4 v25, s[44:47], s68 offen offset:1024 lds
    buffer_load_dwordx4 v26, s[44:47], s68 offen offset:2048 lds
    buffer_load_dwordx4 v27, s[44:47], s68 offen offset:3072 lds
    s_mov_b32 m0, 12288
    s_nop 0
    buffer_load_dwordx4 v28, s[44:47], s68 offen offset:0 lds
    buffer_load_dwordx4 v29, s[44:47], s68 offen offset:1024 lds
    buffer_load_dwordx4 v30, s[44:47], s68 offen offset:2048 lds
    buffer_load_dwordx4 v31, s[44:47], s68 offen offset:3072 lds
    s_barrier
    s_waitcnt vmcnt(48)
    s_add_u32 s68, s64, s66
    s_mov_b32 m0, 30720
    s_nop 0
    buffer_load_dwordx4 v24, s[44:47], s68 offen offset:0 lds
    buffer_load_dwordx4 v25, s[44:47], s68 offen offset:1024 lds
    buffer_load_dwordx4 v26, s[44:47], s68 offen offset:2048 lds
    buffer_load_dwordx4 v27, s[44:47], s68 offen offset:3072 lds
    s_mov_b32 m0, 34816
    s_nop 0
    buffer_load_dwordx4 v28, s[44:47], s68 offen offset:0 lds
    buffer_load_dwordx4 v29, s[44:47], s68 offen offset:1024 lds
    buffer_load_dwordx4 v30, s[44:47], s68 offen offset:2048 lds
    buffer_load_dwordx4 v31, s[44:47], s68 offen offset:3072 lds
    s_add_u32 s68, s65, s66
    s_add_u32 s66, s66, 128
    s_and_b32 s66, s66, 4095
    s_mov_b32 m0, 38912
    s_nop 0
    buffer_load_dwordx4 v24, s[44:47], s68 offen offset:0 lds
    buffer_load_dwordx4 v25, s[44:47], s68 offen offset:1024 lds
    buffer_load_dwordx4 v26, s[44:47], s68 offen offset:2048 lds
    buffer_load_dwordx4 v27, s[44:47], s68 offen offset:3072 lds
    s_mov_b32 m0, 43008
    s_nop 0
    buffer_load_dwordx4 v28, s[44:47], s68 offen offset:0 lds
    buffer_load_dwordx4 v29, s[44:47], s68 offen offset:1024 lds
    buffer_load_dwordx4 v30, s[44:47], s68 offen offset:2048 lds
    buffer_load_dwordx4 v31, s[44:47], s68 offen offset:3072 lds
    s_mov_b32 s70, 61440
AL_M:
    s_mov_b32 s71, 0
    s_barrier
AL_LOOP:
    s_add_u32 s68, s64, s66
    s_add_u32 s69, s65, s66
    s_waitcnt vmcnt(48)
    s_barrier
    s_add_u32 m0, s70, 0
    s_nop 0
    buffer_load_dwordx4 v24, s[44:47], s68 offen offset:0 lds
    buffer_load_dwordx4 v25, s[44:47], s68 offen offset:1024 lds
    buffer_load_dwordx4 v26, s[44:47], s68 offen offset:2048 lds
    buffer_load_dwordx4 v27, s[44:47], s68 offen offset:3072 lds
    s_add_u32 m0, s70, 4096
    s_nop 0
    buffer_load_dwordx4 v28, s[44:47], s68 offen offset:0 lds
    buffer_load_dwordx4 v29, s[44:47], s68 offen offset:1024 lds
    buffer_load_dwordx4 v30, s[44:47], s68 offen offset:2048 lds
    buffer_load_dwordx4 v31, s[44:47], s68 offen offset:3072 lds
    s_add_u32 m0, s70, 8192
    s_nop 0
    buffer_load_dwordx4 v24, s[44:47], s69 offen offset:0 lds
    buffer_load_dwordx4 v25, s[44:47], s69 offen offset:1024 lds
    buffer_load_dwordx4 v26, s[44:47], s69 offen offset:2048 lds
    buffer_load_dwordx4 v27, s[44:47], s69 offen offset:3072 lds
    s_add_u32 m0, s70, 12288
    s_nop 0
    buffer_load_dwordx4 v28, s[44:47], s69 offen offset:0 lds
    buffer_load_dwordx4 v29, s[44:47], s69 offen offset:1024 lds
    buffer_load_dwordx4 v30, s[44:47], s69 offen offset:2048 lds
    buffer_load_dwordx4 v31, s[44:47], s69 offen offset:3072 lds
    s_add_u32 s66, s66, 128
    s_and_b32 s66, s66, 4095
    s_add_u32 s70, s70, 30720
    s_cmp_ge_u32 s70, 153600
    s_cselect_b32 s70, 0, s70
    s_add_u32 s71, s71, 1
    s_cmp_lt_u32 s71, 27
    s_cbranch_scc1 AL_LOOP
    s_waitcnt vmcnt(48)
    s_barrier
    s_waitcnt vmcnt(32)
    s_barrier
    s_waitcnt vmcnt(16)
    s_barrier
    s_lshl_b32 s40, s58, 3
    s_lshr_b32 s41, s59, 2
    s_add_u32 s40, s40, s41
    s_and_b32 s41, s59, 3
    s_mul_i32 s42, s41, 196
    s_mul_i32 s43, s3, 7
    s_add_u32 s42, s42, s43
    s_lshl_b32 s42, s42, 10
    s_add_u32 s42, s42, 20971520
    v_lshlrev_b32 v14, 4, v2
    s_add_u32 s43, s42, 0
    buffer_load_dwordx4 v[144:147], v14, s[32:35], s43 offen offset:0 sc1
    buffer_load_dwordx4 v[148:151], v14, s[32:35], s43 offen offset:1024 sc1
    buffer_load_dwordx4 v[152:155], v14, s[32:35], s43 offen offset:2048 sc1
    buffer_load_dwordx4 v[156:159], v14, s[32:35], s43 offen offset:3072 sc1
    s_add_u32 s43, s42, 4096
    buffer_load_dwordx4 v[160:163], v14, s[32:35], s43 offen offset:0 sc1
    buffer_load_dwordx4 v[164:167], v14, s[32:35], s43 offen offset:1024 sc1
    buffer_load_dwordx4 v[168:171], v14, s[32:35], s43 offen offset:2048 sc1
    s_add_u32 s43, s42, 50176
    buffer_load_dwordx4 v[172:175], v14, s[32:35], s43 offen offset:0 sc1
    buffer_load_dwordx4 v[176:179], v14, s[32:35], s43 offen offset:1024 sc1
    buffer_load_dwordx4 v[180:183], v14, s[32:35], s43 offen offset:2048 sc1
    buffer_load_dwordx4 v[184:187], v14, s[32:35], s43 offen offset:3072 sc1
    s_add_u32 s43, s42, 54272
    buffer_load_dwordx4 v[188:191], v14, s[32:35], s43 offen offset:0 sc1
    buffer_load_dwordx4 v[192:195], v14, s[32:35], s43 offen offset:1024 sc1
    buffer_load_dwordx4 v[196:199], v14, s[32:35], s43 offen offset:2048 sc1
    s_add_u32 s43, s42, 100352
    buffer_load_dwordx4 v[200:203], v14, s[32:35], s43 offen offset:0 sc1
    buffer_load_dwordx4 v[204:207], v14, s[32:35], s43 offen offset:1024 sc1
    buffer_load_dwordx4 v[208:211], v14, s[32:35], s43 offen offset:2048 sc1
    buffer_load_dwordx4 v[212:215], v14, s[32:35], s43 offen offset:3072 sc1
    s_add_u32 s43, s42, 104448
    buffer_load_dwordx4 v[216:219], v14, s[32:35], s43 offen offset:0 sc1
    buffer_load_dwordx4 v[220:223], v14, s[32:35], s43 offen offset:1024 sc1
    buffer_load_dwordx4 v[224:227], v14, s[32:35], s43 offen offset:2048 sc1
    s_add_u32 s43, s42, 150528
    buffer_load_dwordx4 v[228:231], v14, s[32:35], s43 offen offset:0 sc1
    buffer_load_dwordx4 v[232:235], v14, s[32:35], s43 offen offset:1024 sc1
    buffer_load_dwordx4 v[236:239], v14, s[32:35], s43 offen offset:2048 sc1
    buffer_load_dwordx4 v[240:243], v14, s[32:35], s43 offen offset:3072 sc1
    s_add_u32 s43, s42, 154624
    buffer_load_dwordx4 v[244:247], v14, s[32:35], s43 offen offset:0 sc1
    buffer_load_dwordx4 v[248:251], v14, s[32:35], s43 offen offset:1024 sc1
    buffer_load_dwordx4 v[252:255], v14, s[32:35], s43 offen offset:2048 sc1
    s_waitcnt vmcnt(28)
    s_barrier
    s_waitcnt vmcnt(28)
    s_barrier
    s_branch P3
KF_END:
    s_endpgm
KF_BL:
    s_cmp_lt_u32 s58, 4
    s_cbranch_scc0 BL_Y
    v_add_u32 v3, 0, v2
    v_mul_u32_u24 v4, 4682, v3
    v_lshrrev_b32 v4, 16, v4
    v_mul_u32_u24 v10, 14, v4
    v_sub_u32 v3, v3, v10
    v_and_b32 v10, 0x33, v4
    v_and_b32 v11, 4, v4
    v_lshl_or_b32 v10, v11, 1, v10
    v_bfe_u32 v11, v4, 3, 1
    v_lshl_or_b32 v10, v11, 2, v10
    v_mul_u32_u24 v10, 3584, v10
    v_lshl_add_u32 v10, v3, 4, v10
    v_subrev_u32 v16, 0, v10
    v_add_u32 v3, 64, v2
    v_mul_u32_u24 v4, 4682, v3
    v_lshrrev_b32 v4, 16, v4
    v_mul_u32_u24 v10, 14, v4
    v_sub_u32 v3, v3, v10
    v_and_b32 v10, 0x33, v4
    v_and_b32 v11, 4, v4
    v_lshl_or_b32 v10, v11, 1, v10
    v_bfe_u32 v11, v4, 3, 1
    v_lshl_or_b32 v10, v11, 2, v10
    v_mul_u32_u24 v10, 3584, v10
    v_lshl_add_u32 v10, v3, 4, v10
    v_subrev_u32 v17, 1024, v10
    v_add_u32 v3, 128, v2
    v_mul_u32_u24 v4, 4682, v3
    v_lshrrev_b32 v4, 16, v4
    v_mul_u32_u24 v10, 14, v4
    v_sub_u32 v3, v3, v10
    v_and_b32 v10, 0x33, v4
    v_and_b32 v11, 4, v4
    v_lshl_or_b32 v10, v11, 1, v10
    v_bfe_u32 v11, v4, 3, 1
    v_lshl_or_b32 v10, v11, 2, v10
    v_mul_u32_u24 v10, 3584, v10
    v_lshl_add_u32 v10, v3, 4, v10
    v_subrev_u32 v18, 2048, v10
    v_add_u32 v3, 192, v2
    v_mul_u32_u24 v4, 4682, v3
    v_lshrrev_b32 v4, 16, v4
    v_mul_u32_u24 v10, 14, v4
    v_sub_u32 v3, v3, v10
    v_and_b32 v10, 0x33, v4
    v_and_b32 v11, 4, v4
    v_lshl_or_b32 v10, v11, 1, v10
    v_bfe_u32 v11, v4, 3, 1
    v_lshl_or_b32 v10, v11, 2, v10
    v_mul_u32_u24 v10, 3584, v10
    v_lshl_add_u32 v10, v3, 4, v10
    v_subrev_u32 v19, 3072, v10
    v_add_u32 v3, 256, v2
    v_mul_u32_u24 v4, 4682, v3
    v_lshrrev_b32 v4, 16, v4
    v_mul_u32_u24 v10, 14, v4
    v_sub_u32 v3, v3, v10
    v_and_b32 v10, 0x33, v4
    v_and_b32 v11, 4, v4
    v_lshl_or_b32 v10, v11, 1, v10
    v_bfe_u32 v11, v4, 3, 1
    v_lshl_or_b32 v10, v11, 2, v10
    v_mul_u32_u24 v10, 3584, v10
    v_lshl_add_u32 v10, v3, 4, v10
    v_subrev_u32 v20, 0, v10
    v_add_u32 v3, 320, v2
    v_mul_u32_u24 v4, 4682, v3
    v_lshrrev_b32 v4, 16, v4
    v_mul_u32_u24 v10, 14, v4
    v_sub_u32 v3, v3, v10
    v_and_b32 v10, 0x33, v4
    v_and_b32 v11, 4, v4
    v_lshl_or_b32 v10, v11, 1, v10
    v_bfe_u32 v11, v4, 3, 1
    v_lshl_or_b32 v10, v11, 2, v10
    v_mul_u32_u24 v10, 3584, v10
    v_lshl_add_u32 v10, v3, 4, v10
    v_subrev_u32 v21, 1024, v10
    v_add_u32 v3, 384, v2
    v_mul_u32_u24 v4, 4682, v3
    v_lshrrev_b32 v4, 16, v4
    v_mul_u32_u24 v10, 14, v4
    v_sub_u32 v3, v3, v10
    v_and_b32 v10, 0x33, v4
    v_and_b32 v11, 4, v4
    v_lshl_or_b32 v10, v11, 1, v10
    v_bfe_u32 v11, v4, 3, 1
    v_lshl_or_b32 v10, v11, 2, v10
    v_mul_u32_u24 v10, 3584, v10
    v_lshl_add_u32 v10, v3, 4, v10
    v_subrev_u32 v22, 2048, v10
    s_mul_i32 s66, s57, 224
    s_add_u32 s67, s66, 1792
    s_waitcnt lgkmcnt(0)
    s_mov_b32 s44, s16
    s_and_b32 s45, s17, 0xffff
    s_mov_b32 s46, 1605632
    s_mov_b32 s47, 0x20000
    s_add_u32 s68, s67, 0
    s_mov_b32 m0, 16384
    s_nop 0
    buffer_load_dwordx4 v16, s[44:47], s68 offen offset:0 lds
    buffer_load_dwordx4 v17, s[44:47], s68 offen offset:1024 lds
    buffer_load_dwordx4 v18, s[44:47], s68 offen offset:2048 lds
    buffer_load_dwordx4 v19, s[44:47], s68 offen offset:3072 lds
    s_mov_b32 m0, 20480
    s_nop 0
    buffer_load_dwordx4 v20, s[44:47], s68 offen offset:0 lds
    buffer_load_dwordx4 v21, s[44:47], s68 offen offset:1024 lds
    buffer_load_dwordx4 v22, s[44:47], s68 offen offset:2048 lds
    s_add_u32 s68, s67, 114688
    s_mov_b32 m0, 23552
    s_nop 0
    buffer_load_dwordx4 v16, s[44:47], s68 offen offset:0 lds
    buffer_load_dwordx4 v17, s[44:47], s68 offen offset:1024 lds
    buffer_load_dwordx4 v18, s[44:47], s68 offen offset:2048 lds
    buffer_load_dwordx4 v19, s[44:47], s68 offen offset:3072 lds
    s_mov_b32 m0, 27648
    s_nop 0
    buffer_load_dwordx4 v20, s[44:47], s68 offen offset:0 lds
    buffer_load_dwordx4 v21, s[44:47], s68 offen offset:1024 lds
    buffer_load_dwordx4 v22, s[44:47], s68 offen offset:2048 lds
    s_add_u32 s68, s67, 229376
    s_mov_b32 m0, 47104
    s_nop 0
    buffer_load_dwordx4 v16, s[44:47], s68 offen offset:0 lds
    buffer_load_dwordx4 v17, s[44:47], s68 offen offset:1024 lds
    buffer_load_dwordx4 v18, s[44:47], s68 offen offset:2048 lds
    buffer_load_dwordx4 v19, s[44:47], s68 offen offset:3072 lds
    s_mov_b32 m0, 51200
    s_nop 0
    buffer_load_dwordx4 v20, s[44:47], s68 offen offset:0 lds
    buffer_load_dwordx4 v21, s[44:47], s68 offen offset:1024 lds
    buffer_load_dwordx4 v22, s[44:47], s68 offen offset:2048 lds
    s_add_u32 s68, s67, 344064
    s_mov_b32 m0, 54272
    s_nop 0
    buffer_load_dwordx4 v16, s[44:47], s68 offen offset:0 lds
    buffer_load_dwordx4 v17, s[44:47], s68 offen offset:1024 lds
    buffer_load_dwordx4 v18, s[44:47], s68 offen offset:2048 lds
    buffer_load_dwordx4 v19, s[44:47], s68 offen offset:3072 lds
    s_mov_b32 m0, 58368
    s_nop 0
    buffer_load_dwordx4 v20, s[44:47], s68 offen offset:0 lds
    buffer_load_dwordx4 v21, s[44:47], s68 offen offset:1024 lds
    buffer_load_dwordx4 v22, s[44:47], s68 offen offset:2048 lds
    s_add_u32 s68, s67, 458752
    s_mov_b32 m0, 77824
    s_nop 0
    buffer_load_dwordx4 v16, s[44:47], s68 offen offset:0 lds
    buffer_load_dwordx4 v17, s[44:47], s68 offen offset:1024 lds
    buffer_load_dwordx4 v18, s[44:47], s68 offen offset:2048 lds
    buffer_load_dwordx4 v19, s[44:47], s68 offen offset:3072 lds
    s_mov_b32 m0, 81920
    s_nop 0
    buffer_load_dwordx4 v20, s[44:47], s68 offen offset:0 lds
    buffer_load_dwordx4 v21, s[44:47], s68 offen offset:1024 lds
    buffer_load_dwordx4 v22, s[44:47], s68 offen offset:2048 lds
    s_add_u32 s68, s67, 573440
    s_mov_b32 m0, 84992
    s_nop 0
    buffer_load_dwordx4 v16, s[44:47], s68 offen offset:0 lds
    buffer_load_dwordx4 v17, s[44:47], s68 offen offset:1024 lds
    buffer_load_dwordx4 v18, s[44:47], s68 offen offset:2048 lds
    buffer_load_dwordx4 v19, s[44:47], s68 offen offset:3072 lds
    s_mov_b32 m0, 89088
    s_nop 0
    buffer_load_dwordx4 v20, s[44:47], s68 offen offset:0 lds
    buffer_load_dwordx4 v21, s[44:47], s68 offen offset:1024 lds
    buffer_load_dwordx4 v22, s[44:47], s68 offen offset:2048 lds
    s_add_u32 s68, s67, 688128
    s_mov_b32 m0, 108544
    s_nop 0
    buffer_load_dwordx4 v16, s[44:47], s68 offen offset:0 lds
    buffer_load_dwordx4 v17, s[44:47], s68 offen offset:1024 lds
    buffer_load_dwordx4 v18, s[44:47], s68 offen offset:2048 lds
    buffer_load_dwordx4 v19, s[44:47], s68 offen offset:3072 lds
    s_mov_b32 m0, 112640
    s_nop 0
    buffer_load_dwordx4 v20, s[44:47], s68 offen offset:0 lds
    buffer_load_dwordx4 v21, s[44:47], s68 offen offset:1024 lds
    buffer_load_dwordx4 v22, s[44:47], s68 offen offset:2048 lds
    s_add_u32 s68, s67, 802816
    s_mov_b32 m0, 115712
    s_nop 0
    buffer_load_dwordx4 v16, s[44:47], s68 offen offset:0 lds
    buffer_load_dwordx4 v17, s[44:47], s68 offen offset:1024 lds
    buffer_load_dwordx4 v18, s[44:47], s68 offen offset:2048 lds
    buffer_load_dwordx4 v19, s[44:47], s68 offen offset:3072 lds
    s_mov_b32 m0, 119808
    s_nop 0
    buffer_load_dwordx4 v20, s[44:47], s68 offen offset:0 lds
    buffer_load_dwordx4 v21, s[44:47], s68 offen offset:1024 lds
    buffer_load_dwordx4 v22, s[44:47], s68 offen offset:2048 lds
    s_mov_b32 s32, s30
    s_and_b32 s33, s31, 0xffff
    s_mov_b32 s34, 23068672
    s_mov_b32 s35, 0x20000
    s_mov_b32 s36, s28
    s_and_b32 s37, s29, 0xffff
    s_mov_b32 s38, 256
    s_mov_b32 s39, 0x20000
    v_lshlrev_b32 v32, 4, v2
    v_add_u32 v33, 4096, v32
    v_add_u32 v34, 8192, v32
    v_add_u32 v35, 12288, v32
    v_lshlrev_b32 v9, 2, v2
    s_mul_i32 s64, s57, 458752
    s_add_u32 s63, s64, 458752
    s_mul_i32 s65, s99, 14336
    s_add_u32 s65, s65, s64
    s_lshl_b32 s69, s57, 10
    s_add_u32 s69, s69, 22413312
    s_waitcnt vmcnt(42)
    s_barrier
    s_add_u32 s68, s67, 917504
    s_mov_b32 m0, 139264
    s_nop 0
    buffer_load_dwordx4 v16, s[44:47], s68 offen offset:0 lds
    buffer_load_dwordx4 v17, s[44:47], s68 offen offset:1024 lds
    buffer_load_dwordx4 v18, s[44:47], s68 offen offset:2048 lds
    buffer_load_dwordx4 v19, s[44:47], s68 offen offset:3072 lds
    s_mov_b32 m0, 143360
    s_nop 0
    buffer_load_dwordx4 v20, s[44:47], s68 offen offset:0 lds
    buffer_load_dwordx4 v21, s[44:47], s68 offen offset:1024 lds
    buffer_load_dwordx4 v22, s[44:47], s68 offen offset:2048 lds
    s_add_u32 s68, s67, 1032192
    s_mov_b32 m0, 146432
    s_nop 0
    buffer_load_dwordx4 v16, s[44:47], s68 offen offset:0 lds
    buffer_load_dwordx4 v17, s[44:47], s68 offen offset:1024 lds
    buffer_load_dwordx4 v18, s[44:47], s68 offen offset:2048 lds
    buffer_load_dwordx4 v19, s[44:47], s68 offen offset:3072 lds
    s_mov_b32 m0, 150528
    s_nop 0
    buffer_load_dwordx4 v20, s[44:47], s68 offen offset:0 lds
    buffer_load_dwordx4 v21, s[44:47], s68 offen offset:1024 lds
    buffer_load_dwordx4 v22, s[44:47], s68 offen offset:2048 lds
    s_waitcnt vmcnt(42)
    s_barrier
    s_add_u32 s68, s67, 1146880
    s_mov_b32 m0, 16384
    s_nop 0
    buffer_load_dwordx4 v16, s[44:47], s68 offen offset:0 lds
    buffer_load_dwordx4 v17, s[44:47], s68 offen offset:1024 lds
    buffer_load_dwordx4 v18, s[44:47], s68 offen offset:2048 lds
    buffer_load_dwordx4 v19, s[44:47], s68 offen offset:3072 lds
    s_mov_b32 m0, 20480
    s_nop 0
    buffer_load_dwordx4 v20, s[44:47], s68 offen offset:0 lds
    buffer_load_dwordx4 v21, s[44:47], s68 offen offset:1024 lds
    buffer_load_dwordx4 v22, s[44:47], s68 offen offset:2048 lds
    s_add_u32 s68, s67, 1261568
    s_mov_b32 m0, 23552
    s_nop 0
    buffer_load_dwordx4 v16, s[44:47], s68 offen offset:0 lds
    buffer_load_dwordx4 v17, s[44:47], s68 offen offset:1024 lds
    buffer_load_dwordx4 v18, s[44:47], s68 offen offset:2048 lds
    buffer_load_dwordx4 v19, s[44:47], s68 offen offset:3072 lds
    s_mov_b32 m0, 27648
    s_nop 0
    buffer_load_dwordx4 v20, s[44:47], s68 offen offset:0 lds
    buffer_load_dwordx4 v21, s[44:47], s68 offen offset:1024 lds
    buffer_load_dwordx4 v22, s[44:47], s68 offen offset:2048 lds
    s_waitcnt vmcnt(42)
    s_barrier
    s_add_u32 s68, s67, 1376256
    s_mov_b32 m0, 47104
    s_nop 0
    buffer_load_dwordx4 v16, s[44:47], s68 offen offset:0 lds
    buffer_load_dwordx4 v17, s[44:47], s68 offen offset:1024 lds
    buffer_load_dwordx4 v18, s[44:47], s68 offen offset:2048 lds
    buffer_load_dwordx4 v19, s[44:47], s68 offen offset:3072 lds
    s_mov_b32 m0, 51200
    s_nop 0
    buffer_load_dwordx4 v20, s[44:47], s68 offen offset:0 lds
    buffer_load_dwordx4 v21, s[44:47], s68 offen offset:1024 lds
    buffer_load_dwordx4 v22, s[44:47], s68 offen offset:2048 lds
    s_add_u32 s68, s67, 1490944
    s_mov_b32 m0, 54272
    s_nop 0
    buffer_load_dwordx4 v16, s[44:47], s68 offen offset:0 lds
    buffer_load_dwordx4 v17, s[44:47], s68 offen offset:1024 lds
    buffer_load_dwordx4 v18, s[44:47], s68 offen offset:2048 lds
    buffer_load_dwordx4 v19, s[44:47], s68 offen offset:3072 lds
    s_mov_b32 m0, 58368
    s_nop 0
    buffer_load_dwordx4 v20, s[44:47], s68 offen offset:0 lds
    buffer_load_dwordx4 v21, s[44:47], s68 offen offset:1024 lds
    buffer_load_dwordx4 v22, s[44:47], s68 offen offset:2048 lds
    s_waitcnt vmcnt(42)
    s_barrier
    s_add_u32 s68, s66, 0
    s_mov_b32 m0, 77824
    s_nop 0
    buffer_load_dwordx4 v16, s[44:47], s68 offen offset:0 lds
    buffer_load_dwordx4 v17, s[44:47], s68 offen offset:1024 lds
    buffer_load_dwordx4 v18, s[44:47], s68 offen offset:2048 lds
    buffer_load_dwordx4 v19, s[44:47], s68 offen offset:3072 lds
    s_mov_b32 m0, 81920
    s_nop 0
    buffer_load_dwordx4 v20, s[44:47], s68 offen offset:0 lds
    buffer_load_dwordx4 v21, s[44:47], s68 offen offset:1024 lds
    buffer_load_dwordx4 v22, s[44:47], s68 offen offset:2048 lds
    s_add_u32 s68, s66, 114688
    s_mov_b32 m0, 84992
    s_nop 0
    buffer_load_dwordx4 v16, s[44:47], s68 offen offset:0 lds
    buffer_load_dwordx4 v17, s[44:47], s68 offen offset:1024 lds
    buffer_load_dwordx4 v18, s[44:47], s68 offen offset:2048 lds
    buffer_load_dwordx4 v19, s[44:47], s68 offen offset:3072 lds
    s_mov_b32 m0, 89088
    s_nop 0
    buffer_load_dwordx4 v20, s[44:47], s68 offen offset:0 lds
    buffer_load_dwordx4 v21, s[44:47], s68 offen offset:1024 lds
    buffer_load_dwordx4 v22, s[44:47], s68 offen offset:2048 lds
    s_waitcnt vmcnt(42)
    s_barrier
    s_add_u32 s68, s66, 229376
    s_mov_b32 m0, 108544
    s_nop 0
    buffer_load_dwordx4 v16, s[44:47], s68 offen offset:0 lds
    buffer_load_dwordx4 v17, s[44:47], s68 offen offset:1024 lds
    buffer_load_dwordx4 v18, s[44:47], s68 offen offset:2048 lds
    buffer_load_dwordx4 v19, s[44:47], s68 offen offset:3072 lds
    s_mov_b32 m0, 112640
    s_nop 0
    buffer_load_dwordx4 v20, s[44:47], s68 offen offset:0 lds
    buffer_load_dwordx4 v21, s[44:47], s68 offen offset:1024 lds
    buffer_load_dwordx4 v22, s[44:47], s68 offen offset:2048 lds
    s_add_u32 s68, s66, 344064
    s_mov_b32 m0, 115712
    s_nop 0
    buffer_load_dwordx4 v16, s[44:47], s68 offen offset:0 lds
    buffer_load_dwordx4 v17, s[44:47], s68 offen offset:1024 lds
    buffer_load_dwordx4 v18, s[44:47], s68 offen offset:2048 lds
    buffer_load_dwordx4 v19, s[44:47], s68 offen offset:3072 lds
    s_mov_b32 m0, 119808
    s_nop 0
    buffer_load_dwordx4 v20, s[44:47], s68 offen offset:0 lds
    buffer_load_dwordx4 v21, s[44:47], s68 offen offset:1024 lds
    buffer_load_dwordx4 v22, s[44:47], s68 offen offset:2048 lds
    s_waitcnt vmcnt(42)
    s_barrier
    s_add_u32 s68, s66, 458752
    s_mov_b32 m0, 139264
    s_nop 0
    buffer_load_dwordx4 v16, s[44:47], s68 offen offset:0 lds
    buffer_load_dwordx4 v17, s[44:47], s68 offen offset:1024 lds
    buffer_load_dwordx4 v18, s[44:47], s68 offen offset:2048 lds
    buffer_load_dwordx4 v19, s[44:47], s68 offen offset:3072 lds
    s_mov_b32 m0, 143360
    s_nop 0
    buffer_load_dwordx4 v20, s[44:47], s68 offen offset:0 lds
    buffer_load_dwordx4 v21, s[44:47], s68 offen offset:1024 lds
    buffer_load_dwordx4 v22, s[44:47], s68 offen offset:2048 lds
    s_add_u32 s68, s66, 573440
    s_mov_b32 m0, 146432
    s_nop 0
    buffer_load_dwordx4 v16, s[44:47], s68 offen offset:0 lds
    buffer_load_dwordx4 v17, s[44:47], s68 offen offset:1024 lds
    buffer_load_dwordx4 v18, s[44:47], s68 offen offset:2048 lds
    buffer_load_dwordx4 v19, s[44:47], s68 offen offset:3072 lds
    s_mov_b32 m0, 150528
    s_nop 0
    buffer_load_dwordx4 v20, s[44:47], s68 offen offset:0 lds
    buffer_load_dwordx4 v21, s[44:47], s68 offen offset:1024 lds
    buffer_load_dwordx4 v22, s[44:47], s68 offen offset:2048 lds
    s_waitcnt vmcnt(42)
    s_barrier
    s_add_u32 s68, s66, 688128
    s_mov_b32 m0, 16384
    s_nop 0
    buffer_load_dwordx4 v16, s[44:47], s68 offen offset:0 lds
    buffer_load_dwordx4 v17, s[44:47], s68 offen offset:1024 lds
    buffer_load_dwordx4 v18, s[44:47], s68 offen offset:2048 lds
    buffer_load_dwordx4 v19, s[44:47], s68 offen offset:3072 lds
    s_mov_b32 m0, 20480
    s_nop 0
    buffer_load_dwordx4 v20, s[44:47], s68 offen offset:0 lds
    buffer_load_dwordx4 v21, s[44:47], s68 offen offset:1024 lds
    buffer_load_dwordx4 v22, s[44:47], s68 offen offset:2048 lds
    s_add_u32 s68, s66, 802816
    s_mov_b32 m0, 23552
    s_nop 0
    buffer_load_dwordx4 v16, s[44:47], s68 offen offset:0 lds
    buffer_load_dwordx4 v17, s[44:47], s68 offen offset:1024 lds
    buffer_load_dwordx4 v18, s[44:47], s68 offen offset:2048 lds
    buffer_load_dwordx4 v19, s[44:47], s68 offen offset:3072 lds
    s_mov_b32 m0, 27648
    s_nop 0
    buffer_load_dwordx4 v20, s[44:47], s68 offen offset:0 lds
    buffer_load_dwordx4 v21, s[44:47], s68 offen offset:1024 lds
    buffer_load_dwordx4 v22, s[44:47], s68 offen offset:2048 lds
    s_waitcnt vmcnt(42)
    s_barrier
    s_add_u32 s68, s66, 917504
    s_mov_b32 m0, 47104
    s_nop 0
    buffer_load_dwordx4 v16, s[44:47], s68 offen offset:0 lds
    buffer_load_dwordx4 v17, s[44:47], s68 offen offset:1024 lds
    buffer_load_dwordx4 v18, s[44:47], s68 offen offset:2048 lds
    buffer_load_dwordx4 v19, s[44:47], s68 offen offset:3072 lds
    s_mov_b32 m0, 51200
    s_nop 0
    buffer_load_dwordx4 v20, s[44:47], s68 offen offset:0 lds
    buffer_load_dwordx4 v21, s[44:47], s68 offen offset:1024 lds
    buffer_load_dwordx4 v22, s[44:47], s68 offen offset:2048 lds
    s_add_u32 s68, s66, 1032192
    s_mov_b32 m0, 54272
    s_nop 0
    buffer_load_dwordx4 v16, s[44:47], s68 offen offset:0 lds
    buffer_load_dwordx4 v17, s[44:47], s68 offen offset:1024 lds
    buffer_load_dwordx4 v18, s[44:47], s68 offen offset:2048 lds
    buffer_load_dwordx4 v19, s[44:47], s68 offen offset:3072 lds
    s_mov_b32 m0, 58368
    s_nop 0
    buffer_load_dwordx4 v20, s[44:47], s68 offen offset:0 lds
    buffer_load_dwordx4 v21, s[44:47], s68 offen offset:1024 lds
    buffer_load_dwordx4 v22, s[44:47], s68 offen offset:2048 lds
    s_waitcnt vmcnt(42)
    s_barrier
    s_add_u32 s68, s66, 1146880
    s_mov_b32 m0, 77824
    s_nop 0
    buffer_load_dwordx4 v16, s[44:47], s68 offen offset:0 lds
    buffer_load_dwordx4 v17, s[44:47], s68 offen offset:1024 lds
    buffer_load_dwordx4 v18, s[44:47], s68 offen offset:2048 lds
    buffer_load_dwordx4 v19, s[44:47], s68 offen offset:3072 lds
    s_mov_b32 m0, 81920
    s_nop 0
    buffer_load_dwordx4 v20, s[44:47], s68 offen offset:0 lds
    buffer_load_dwordx4 v21, s[44:47], s68 offen offset:1024 lds
    buffer_load_dwordx4 v22, s[44:47], s68 offen offset:2048 lds
    s_add_u32 s68, s66, 1261568
    s_mov_b32 m0, 84992
    s_nop 0
    buffer_load_dwordx4 v16, s[44:47], s68 offen offset:0 lds
    buffer_load_dwordx4 v17, s[44:47], s68 offen offset:1024 lds
    buffer_load_dwordx4 v18, s[44:47], s68 offen offset:2048 lds
    buffer_load_dwordx4 v19, s[44:47], s68 offen offset:3072 lds
    s_mov_b32 m0, 89088
    s_nop 0
    buffer_load_dwordx4 v20, s[44:47], s68 offen offset:0 lds
    buffer_load_dwordx4 v21, s[44:47], s68 offen offset:1024 lds
    buffer_load_dwordx4 v22, s[44:47], s68 offen offset:2048 lds
    s_waitcnt vmcnt(42)
    s_barrier
    s_add_u32 s68, s66, 1376256
    s_mov_b32 m0, 108544
    s_nop 0
    buffer_load_dwordx4 v16, s[44:47], s68 offen offset:0 lds
    buffer_load_dwordx4 v17, s[44:47], s68 offen offset:1024 lds
    buffer_load_dwordx4 v18, s[44:47], s68 offen offset:2048 lds
    buffer_load_dwordx4 v19, s[44:47], s68 offen offset:3072 lds
    s_mov_b32 m0, 112640
    s_nop 0
    buffer_load_dwordx4 v20, s[44:47], s68 offen offset:0 lds
    buffer_load_dwordx4 v21, s[44:47], s68 offen offset:1024 lds
    buffer_load_dwordx4 v22, s[44:47], s68 offen offset:2048 lds
    s_add_u32 s68, s66, 1490944
    s_mov_b32 m0, 115712
    s_nop 0
    buffer_load_dwordx4 v16, s[44:47], s68 offen offset:0 lds
    buffer_load_dwordx4 v17, s[44:47], s68 offen offset:1024 lds
    buffer_load_dwordx4 v18, s[44:47], s68 offen offset:2048 lds
    buffer_load_dwordx4 v19, s[44:47], s68 offen offset:3072 lds
    s_mov_b32 m0, 119808
    s_nop 0
    buffer_load_dwordx4 v20, s[44:47], s68 offen offset:0 lds
    buffer_load_dwordx4 v21, s[44:47], s68 offen offset:1024 lds
    buffer_load_dwordx4 v22, s[44:47], s68 offen offset:2048 lds
    s_waitcnt vmcnt(42)
    s_barrier
    s_waitcnt vmcnt(28)
    s_barrier
    s_waitcnt vmcnt(14)
    s_barrier
    s_waitcnt vmcnt(0)
    s_barrier
    s_barrier
    s_mov_b32 s70, 122880
    s_branch BL_M
BL_Y:
    v_lshrrev_b32 v3, 3, v2
    v_and_b32 v4, 4, v3
    v_and_b32 v3, 3, v3
    v_lshl_or_b32 v3, v4, 1, v3
    v_mul_u32_u24 v3, 896, v3
    v_and_b32 v4, 7, v2
    v_lshrrev_b32 v5, 4, v2
    v_xor_b32 v4, v4, v5
    v_lshlrev_b32 v4, 4, v4
    v_add_u32 v5, v3, v4
    v_xor_b32 v4, 64, v4
    v_add_u32 v6, v3, v4
    v_lshrrev_b32 v3, 3, v2
    v_mul_u32_u24 v3, 896, v3
    v_and_b32 v4, 7, v2
    v_lshrrev_b32 v7, 4, v2
    v_xor_b32 v4, v4, v7
    v_lshlrev_b32 v4, 4, v4
    v_add_u32 v7, v3, v4
    v_xor_b32 v4, 64, v4
    v_add_u32 v8, v3, v4
    v_add_u32 v16, 0, v5
    v_add_u32 v17, 13312, v6
    v_add_u32 v18, 1536, v5
    v_add_u32 v19, 14848, v6
    v_add_u32 v20, 28672, v5
    v_add_u32 v21, 41984, v6
    v_add_u32 v22, 30208, v5
    v_add_u32 v23, 43520, v6
    v_add_u32 v24, 57344, v5
    v_add_u32 v25, 70656, v6
    v_add_u32 v26, 58880, v5
    v_add_u32 v27, 72192, v6
    v_add_u32 v28, 86016, v7
    v_add_u32 v29, 92160, v8
    s_and_b32 s66, s57, 3
    s_mul_i32 s66, s66, 100352
    s_waitcnt lgkmcnt(0)
    s_cmp_lt_u32 s57, 12
    s_cselect_b32 s70, s10, s12
    s_cselect_b32 s71, s11, s13
    s_mov_b32 s44, s70
    s_and_b32 s45, s71, 0xffff
    s_mov_b32 s46, 401408
    s_mov_b32 s47, 0x20000
    s_add_u32 s68, s66, 0
    s_mov_b32 m0, 16384
    s_nop 0
    buffer_load_dwordx4 v16, s[44:47], s68 offen offset:0 lds
    buffer_load_dwordx4 v17, s[44:47], s68 offen offset:1024 lds
    buffer_load_dwordx4 v18, s[44:47], s68 offen offset:2048 lds
    buffer_load_dwordx4 v19, s[44:47], s68 offen offset:3072 lds
    s_mov_b32 m0, 20480
    s_nop 0
    buffer_load_dwordx4 v20, s[44:47], s68 offen offset:0 lds
    buffer_load_dwordx4 v21, s[44:47], s68 offen offset:1024 lds
    buffer_load_dwordx4 v22, s[44:47], s68 offen offset:2048 lds
    buffer_load_dwordx4 v23, s[44:47], s68 offen offset:3072 lds
    s_mov_b32 m0, 24576
    s_nop 0
    buffer_load_dwordx4 v24, s[44:47], s68 offen offset:0 lds
    buffer_load_dwordx4 v25, s[44:47], s68 offen offset:1024 lds
    buffer_load_dwordx4 v26, s[44:47], s68 offen offset:2048 lds
    buffer_load_dwordx4 v27, s[44:47], s68 offen offset:3072 lds
    s_mov_b32 m0, 28672
    s_nop 0
    buffer_load_dwordx4 v28, s[44:47], s68 offen offset:0 lds
    buffer_load_dwordx4 v29, s[44:47], s68 offen offset:1024 lds
    s_add_u32 s68, s66, 128
    s_mov_b32 m0, 47104
    s_nop 0
    buffer_load_dwordx4 v16, s[44:47], s68 offen offset:0 lds
    buffer_load_dwordx4 v17, s[44:47], s68 offen offset:1024 lds
    buffer_load_dwordx4 v18, s[44:47], s68 offen offset:2048 lds
    buffer_load_dwordx4 v19, s[44:47], s68 offen offset:3072 lds
    s_mov_b32 m0, 51200
    s_nop 0
    buffer_load_dwordx4 v20, s[44:47], s68 offen offset:0 lds
    buffer_load_dwordx4 v21, s[44:47], s68 offen offset:1024 lds
    buffer_load_dwordx4 v22, s[44:47], s68 offen offset:2048 lds
    buffer_load_dwordx4 v23, s[44:47], s68 offen offset:3072 lds
    s_mov_b32 m0, 55296
    s_nop 0
    buffer_load_dwordx4 v24, s[44:47], s68 offen offset:0 lds
    buffer_load_dwordx4 v25, s[44:47], s68 offen offset:1024 lds
    buffer_load_dwordx4 v26, s[44:47], s68 offen offset:2048 lds
    buffer_load_dwordx4 v27, s[44:47], s68 offen offset:3072 lds
    s_mov_b32 m0, 59392
    s_nop 0
    buffer_load_dwordx4 v28, s[44:47], s68 offen offset:0 lds
    buffer_load_dwordx4 v29, s[44:47], s68 offen offset:1024 lds
    s_add_u32 s68, s66, 256
    s_mov_b32 m0, 77824
    s_nop 0
    buffer_load_dwordx4 v16, s[44:47], s68 offen offset:0 lds
    buffer_load_dwordx4 v17, s[44:47], s68 offen offset:1024 lds
    buffer_load_dwordx4 v18, s[44:47], s68 offen offset:2048 lds
    buffer_load_dwordx4 v19, s[44:47], s68 offen offset:3072 lds
    s_mov_b32 m0, 81920
    s_nop 0
    buffer_load_dwordx4 v20, s[44:47], s68 offen offset:0 lds
    buffer_load_dwordx4 v21, s[44:47], s68 offen offset:1024 lds
    buffer_load_dwordx4 v22, s[44:47], s68 offen offset:2048 lds
    buffer_load_dwordx4 v23, s[44:47], s68 offen offset:3072 lds
    s_mov_b32 m0, 86016
    s_nop 0
    buffer_load_dwordx4 v24, s[44:47], s68 offen offset:0 lds
    buffer_load_dwordx4 v25, s[44:47], s68 offen offset:1024 lds
    buffer_load_dwordx4 v26, s[44:47], s68 offen offset:2048 lds
    buffer_load_dwordx4 v27, s[44:47], s68 offen offset:3072 lds
    s_mov_b32 m0, 90112
    s_nop 0
    buffer_load_dwordx4 v28, s[44:47], s68 offen offset:0 lds
    buffer_load_dwordx4 v29, s[44:47], s68 offen offset:1024 lds
    s_add_u32 s68, s66, 384
    s_mov_b32 m0, 108544
    s_nop 0
    buffer_load_dwordx4 v16, s[44:47], s68 offen offset:0 lds
    buffer_load_dwordx4 v17, s[44:47], s68 offen offset:1024 lds
    buffer_load_dwordx4 v18, s[44:47], s68 offen offset:2048 lds
    buffer_load_dwordx4 v19, s[44:47], s68 offen offset:3072 lds
    s_mov_b32 m0, 112640
    s_nop 0
    buffer_load_dwordx4 v20, s[44:47], s68 offen offset:0 lds
    buffer_load_dwordx4 v21, s[44:47], s68 offen offset:1024 lds
    buffer_load_dwordx4 v22, s[44:47], s68 offen offset:2048 lds
    buffer_load_dwordx4 v23, s[44:47], s68 offen offset:3072 lds
    s_mov_b32 m0, 116736
    s_nop 0
    buffer_load_dwordx4 v24, s[44:47], s68 offen offset:0 lds
    buffer_load_dwordx4 v25, s[44:47], s68 offen offset:1024 lds
    buffer_load_dwordx4 v26, s[44:47], s68 offen offset:2048 lds
    buffer_load_dwordx4 v27, s[44:47], s68 offen offset:3072 lds
    s_mov_b32 m0, 120832
    s_nop 0
    buffer_load_dwordx4 v28, s[44:47], s68 offen offset:0 lds
    buffer_load_dwordx4 v29, s[44:47], s68 offen offset:1024 lds
    s_mov_b32 s32, s30
    s_and_b32 s33, s31, 0xffff
    s_mov_b32 s34, 23068672
    s_mov_b32 s35, 0x20000
    s_mov_b32 s36, s28
    s_and_b32 s37, s29, 0xffff
    s_mov_b32 s38, 256
    s_mov_b32 s39, 0x20000
    v_lshlrev_b32 v32, 4, v2
    v_add_u32 v33, 4096, v32
    v_add_u32 v34, 8192, v32
    v_add_u32 v35, 12288, v32
    v_lshlrev_b32 v9, 2, v2
    s_mul_i32 s64, s57, 458752
    s_add_u32 s63, s64, 458752
    s_mul_i32 s65, s99, 14336
    s_add_u32 s65, s65, s64
    s_lshl_b32 s69, s57, 10
    s_add_u32 s69, s69, 22413312
    s_waitcnt vmcnt(42)
    s_barrier
    s_add_u32 s68, s66, 512
    s_mov_b32 m0, 139264
    s_nop 0
    buffer_load_dwordx4 v16, s[44:47], s68 offen offset:0 lds
    buffer_load_dwordx4 v17, s[44:47], s68 offen offset:1024 lds
    buffer_load_dwordx4 v18, s[44:47], s68 offen offset:2048 lds
    buffer_load_dwordx4 v19, s[44:47], s68 offen offset:3072 lds
    s_mov_b32 m0, 143360
    s_nop 0
    buffer_load_dwordx4 v20, s[44:47], s68 offen offset:0 lds
    buffer_load_dwordx4 v21, s[44:47], s68 offen offset:1024 lds
    buffer_load_dwordx4 v22, s[44:47], s68 offen offset:2048 lds
    buffer_load_dwordx4 v23, s[44:47], s68 offen offset:3072 lds
    s_mov_b32 m0, 147456
    s_nop 0
    buffer_load_dwordx4 v24, s[44:47], s68 offen offset:0 lds
    buffer_load_dwordx4 v25, s[44:47], s68 offen offset:1024 lds
    buffer_load_dwordx4 v26, s[44:47], s68 offen offset:2048 lds
    buffer_load_dwordx4 v27, s[44:47], s68 offen offset:3072 lds
    s_mov_b32 m0, 151552
    s_nop 0
    buffer_load_dwordx4 v28, s[44:47], s68 offen offset:0 lds
    buffer_load_dwordx4 v29, s[44:47], s68 offen offset:1024 lds
    s_waitcnt vmcnt(42)
    s_barrier
    s_add_u32 s68, s66, 640
    s_mov_b32 m0, 16384
    s_nop 0
    buffer_load_dwordx4 v16, s[44:47], s68 offen offset:0 lds
    buffer_load_dwordx4 v17, s[44:47], s68 offen offset:1024 lds
    buffer_load_dwordx4 v18, s[44:47], s68 offen offset:2048 lds
    buffer_load_dwordx4 v19, s[44:47], s68 offen offset:3072 lds
    s_mov_b32 m0, 20480
    s_nop 0
    buffer_load_dwordx4 v20, s[44:47], s68 offen offset:0 lds
    buffer_load_dwordx4 v21, s[44:47], s68 offen offset:1024 lds
    buffer_load_dwordx4 v22, s[44:47], s68 offen offset:2048 lds
    buffer_load_dwordx4 v23, s[44:47], s68 offen offset:3072 lds
    s_mov_b32 m0, 24576
    s_nop 0
    buffer_load_dwordx4 v24, s[44:47], s68 offen offset:0 lds
    buffer_load_dwordx4 v25, s[44:47], s68 offen offset:1024 lds
    buffer_load_dwordx4 v26, s[44:47], s68 offen offset:2048 lds
    buffer_load_dwordx4 v27, s[44:47], s68 offen offset:3072 lds
    s_mov_b32 m0, 28672
    s_nop 0
    buffer_load_dwordx4 v28, s[44:47], s68 offen offset:0 lds
    buffer_load_dwordx4 v29, s[44:47], s68 offen offset:1024 lds
    s_waitcnt vmcnt(42)
    s_barrier
    s_add_u32 s68, s66, 768
    s_mov_b32 m0, 47104
    s_nop 0
    buffer_load_dwordx4 v16, s[44:47], s68 offen offset:0 lds
    buffer_load_dwordx4 v17, s[44:47], s68 offen offset:1024 lds
    buffer_load_dwordx4 v18, s[44:47], s68 offen offset:2048 lds
    buffer_load_dwordx4 v19, s[44:47], s68 offen offset:3072 lds
    s_mov_b32 m0, 51200
    s_nop 0
    buffer_load_dwordx4 v20, s[44:47], s68 offen offset:0 lds
    buffer_load_dwordx4 v21, s[44:47], s68 offen offset:1024 lds
    buffer_load_dwordx4 v22, s[44:47], s68 offen offset:2048 lds
    buffer_load_dwordx4 v23, s[44:47], s68 offen offset:3072 lds
    s_mov_b32 m0, 55296
    s_nop 0
    buffer_load_dwordx4 v24, s[44:47], s68 offen offset:0 lds
    buffer_load_dwordx4 v25, s[44:47], s68 offen offset:1024 lds
    buffer_load_dwordx4 v26, s[44:47], s68 offen offset:2048 lds
    buffer_load_dwordx4 v27, s[44:47], s68 offen offset:3072 lds
    s_mov_b32 m0, 59392
    s_nop 0
    buffer_load_dwordx4 v28, s[44:47], s68 offen offset:0 lds
    buffer_load_dwordx4 v29, s[44:47], s68 offen offset:1024 lds
    s_waitcnt vmcnt(42)
    s_barrier
    s_waitcnt vmcnt(28)
    s_barrier
    s_waitcnt vmcnt(14)
    s_barrier
    s_waitcnt vmcnt(0)
    s_barrier
    s_barrier
    s_mov_b32 s70, 61440
BL_M:
    s_mov_b32 s78, 0
    s_mov_b64 s[72:73], -1
    s_mov_b64 s[74:75], 0
    s_mov_b32 s78, 0
BL0_POLL:
    buffer_load_dword v4, v9, s[32:35], s69 offen sc1
    s_waitcnt vmcnt(0)
    v_cmp_eq_u32 vcc, 0, v4
    s_cmp_eq_u64 vcc, 0
    s_cbranch_scc1 BL0_GO
    s_mov_b64 exec, vcc
    s_add_u32 s78, s78, 1
    s_cmp_ge_u32 s78, 0x40000
    s_cbranch_scc1 BL0_GO
    s_sleep 8
    s_cmp_lt_u32 s58, 4
    s_cbranch_scc1 BL0_POLL
    s_sleep 24
    s_branch BL0_POLL
BL0_GO:
    s_mov_b64 exec, -1
    s_add_u32 m0, s70, 16384
    s_nop 0
    buffer_load_dwordx4 v32, s[32:35], s65 offen offset:0 sc1 lds
    buffer_load_dwordx4 v32, s[32:35], s65 offen offset:1024 sc1 lds
    buffer_load_dwordx4 v32, s[32:35], s65 offen offset:2048 sc1 lds
    buffer_load_dwordx4 v32, s[32:35], s65 offen offset:3072 sc1 lds
    s_add_u32 m0, s70, 20480
    s_nop 0
    buffer_load_dwordx4 v33, s[32:35], s65 offen offset:0 sc1 lds
    buffer_load_dwordx4 v33, s[32:35], s65 offen offset:1024 sc1 lds
    buffer_load_dwordx4 v33, s[32:35], s65 offen offset:2048 sc1 lds
    buffer_load_dwordx4 v33, s[32:35], s65 offen offset:3072 sc1 lds
    s_add_u32 m0, s70, 24576
    s_nop 0
    buffer_load_dwordx4 v34, s[32:35], s65 offen offset:0 sc1 lds
    buffer_load_dwordx4 v34, s[32:35], s65 offen offset:1024 sc1 lds
    buffer_load_dwordx4 v34, s[32:35], s65 offen offset:2048 sc1 lds
    buffer_load_dwordx4 v34, s[32:35], s65 offen offset:3072 sc1 lds
    s_add_u32 m0, s70, 28672
    s_nop 0
    buffer_load_dwordx4 v35, s[32:35], s65 offen offset:0 sc1 lds
    buffer_load_dwordx4 v35, s[32:35], s65 offen offset:1024 sc1 lds
    s_add_u32 s65, s65, 14336
    s_cmp_ge_u32 s65, s63
    s_cselect_b32 s65, s64, s65
    s_add_u32 s70, s70, 30720
    s_cmp_ge_u32 s70, 153600
    s_cselect_b32 s70, 0, s70
    s_add_u32 m0, s70, 16384
    s_nop 0
    buffer_load_dwordx4 v32, s[32:35], s65 offen offset:0 sc1 lds
    buffer_load_dwordx4 v32, s[32:35], s65 offen offset:1024 sc1 lds
    buffer_load_dwordx4 v32, s[32:35], s65 offen offset:2048 sc1 lds
    buffer_load_dwordx4 v32, s[32:35], s65 offen offset:3072 sc1 lds
    s_add_u32 m0, s70, 20480
    s_nop 0
    buffer_load_dwordx4 v33, s[32:35], s65 offen offset:0 sc1 lds
    buffer_load_dwordx4 v33, s[32:35], s65 offen offset:1024 sc1 lds
    buffer_load_dwordx4 v33, s[32:35], s65 offen offset:2048 sc1 lds
    buffer_load_dwordx4 v33, s[32:35], s65 offen offset:3072 sc1 lds
    s_add_u32 m0, s70, 24576
    s_nop 0
    buffer_load_dwordx4 v34, s[32:35], s65 offen offset:0 sc1 lds
    buffer_load_dwordx4 v34, s[32:35], s65 offen offset:1024 sc1 lds
    buffer_load_dwordx4 v34, s[32:35], s65 offen offset:2048 sc1 lds
    buffer_load_dwordx4 v34, s[32:35], s65 offen offset:3072 sc1 lds
    s_add_u32 m0, s70, 28672
    s_nop 0
    buffer_load_dwordx4 v35, s[32:35], s65 offen offset:0 sc1 lds
    buffer_load_dwordx4 v35, s[32:35], s65 offen offset:1024 sc1 lds
    s_add_u32 s65, s65, 14336
    s_cmp_ge_u32 s65, s63
    s_cselect_b32 s65, s64, s65
    s_add_u32 s70, s70, 30720
    s_cmp_ge_u32 s70, 153600
    s_cselect_b32 s70, 0, s70
    s_add_u32 m0, s70, 16384
    s_nop 0
    buffer_load_dwordx4 v32, s[32:35], s65 offen offset:0 sc1 lds
    buffer_load_dwordx4 v32, s[32:35], s65 offen offset:1024 sc1 lds
    buffer_load_dwordx4 v32, s[32:35], s65 offen offset:2048 sc1 lds
    buffer_load_dwordx4 v32, s[32:35], s65 offen offset:3072 sc1 lds
    s_add_u32 m0, s70, 20480
    s_nop 0
    buffer_load_dwordx4 v33, s[32:35], s65 offen offset:0 sc1 lds
    buffer_load_dwordx4 v33, s[32:35], s65 offen offset:1024 sc1 lds
    buffer_load_dwordx4 v33, s[32:35], s65 offen offset:2048 sc1 lds
    buffer_load_dwordx4 v33, s[32:35], s65 offen offset:3072 sc1 lds
    s_add_u32 m0, s70, 24576
    s_nop 0
    buffer_load_dwordx4 v34, s[32:35], s65 offen offset:0 sc1 lds
    buffer_load_dwordx4 v34, s[32:35], s65 offen offset:1024 sc1 lds
    buffer_load_dwordx4 v34, s[32:35], s65 offen offset:2048 sc1 lds
    buffer_load_dwordx4 v34, s[32:35], s65 offen offset:3072 sc1 lds
    s_add_u32 m0, s70, 28672
    s_nop 0
    buffer_load_dwordx4 v35, s[32:35], s65 offen offset:0 sc1 lds
    buffer_load_dwordx4 v35, s[32:35], s65 offen offset:1024 sc1 lds
    s_add_u32 s65, s65, 14336
    s_cmp_ge_u32 s65, s63
    s_cselect_b32 s65, s64, s65
    s_add_u32 s70, s70, 30720
    s_cmp_ge_u32 s70, 153600
    s_cselect_b32 s70, 0, s70
    s_add_u32 m0, s70, 16384
    s_nop 0
    buffer_load_dwordx4 v32, s[32:35], s65 offen offset:0 sc1 lds
    buffer_load_dwordx4 v32, s[32:35], s65 offen offset:1024 sc1 lds
    buffer_load_dwordx4 v32, s[32:35], s65 offen offset:2048 sc1 lds
    buffer_load_dwordx4 v32, s[32:35], s65 offen offset:3072 sc1 lds
    s_add_u32 m0, s70, 20480
    s_nop 0
    buffer_load_dwordx4 v33, s[32:35], s65 offen offset:0 sc1 lds
    buffer_load_dwordx4 v33, s[32:35], s65 offen offset:1024 sc1 lds
    buffer_load_dwordx4 v33, s[32:35], s65 offen offset:2048 sc1 lds
    buffer_load_dwordx4 v33, s[32:35], s65 offen offset:3072 sc1 lds
    s_add_u32 m0, s70, 24576
    s_nop 0
    buffer_load_dwordx4 v34, s[32:35], s65 offen offset:0 sc1 lds
    buffer_load_dwordx4 v34, s[32:35], s65 offen offset:1024 sc1 lds
    buffer_load_dwordx4 v34, s[32:35], s65 offen offset:2048 sc1 lds
    buffer_load_dwordx4 v34, s[32:35], s65 offen offset:3072 sc1 lds
    s_add_u32 m0, s70, 28672
    s_nop 0
    buffer_load_dwordx4 v35, s[32:35], s65 offen offset:0 sc1 lds
    buffer_load_dwordx4 v35, s[32:35], s65 offen offset:1024 sc1 lds
    s_add_u32 s65, s65, 14336
    s_cmp_ge_u32 s65, s63
    s_cselect_b32 s65, s64, s65
    s_add_u32 s70, s70, 30720
    s_cmp_ge_u32 s70, 153600
    s_cselect_b32 s70, 0, s70
    s_waitcnt vmcnt(42)
    s_barrier
    s_add_u32 m0, s70, 16384
    s_nop 0
    buffer_load_dwordx4 v32, s[32:35], s65 offen offset:0 sc1 lds
    buffer_load_dwordx4 v32, s[32:35], s65 offen offset:1024 sc1 lds
    buffer_load_dwordx4 v32, s[32:35], s65 offen offset:2048 sc1 lds
    buffer_load_dwordx4 v32, s[32:35], s65 offen offset:3072 sc1 lds
    s_add_u32 m0, s70, 20480
    s_nop 0
    buffer_load_dwordx4 v33, s[32:35], s65 offen offset:0 sc1 lds
    buffer_load_dwordx4 v33, s[32:35], s65 offen offset:1024 sc1 lds
    buffer_load_dwordx4 v33, s[32:35], s65 offen offset:2048 sc1 lds
    buffer_load_dwordx4 v33, s[32:35], s65 offen offset:3072 sc1 lds
    s_add_u32 m0, s70, 24576
    s_nop 0
    buffer_load_dwordx4 v34, s[32:35], s65 offen offset:0 sc1 lds
    buffer_load_dwordx4 v34, s[32:35], s65 offen offset:1024 sc1 lds
    buffer_load_dwordx4 v34, s[32:35], s65 offen offset:2048 sc1 lds
    buffer_load_dwordx4 v34, s[32:35], s65 offen offset:3072 sc1 lds
    s_add_u32 m0, s70, 28672
    s_nop 0
    buffer_load_dwordx4 v35, s[32:35], s65 offen offset:0 sc1 lds
    buffer_load_dwordx4 v35, s[32:35], s65 offen offset:1024 sc1 lds
    s_add_u32 s65, s65, 14336
    s_cmp_ge_u32 s65, s63
    s_cselect_b32 s65, s64, s65
    s_add_u32 s70, s70, 30720
    s_cmp_ge_u32 s70, 153600
    s_cselect_b32 s70, 0, s70
    s_mov_b32 s71, 0
BL_LOOP:
    s_waitcnt vmcnt(42)
    s_barrier
    s_add_u32 m0, s70, 16384
    s_nop 0
    buffer_load_dwordx4 v32, s[32:35], s65 offen offset:0 sc1 lds
    buffer_load_dwordx4 v32, s[32:35], s65 offen offset:1024 sc1 lds
    buffer_load_dwordx4 v32, s[32:35], s65 offen offset:2048 sc1 lds
    buffer_load_dwordx4 v32, s[32:35], s65 offen offset:3072 sc1 lds
    s_add_u32 m0, s70, 20480
    s_nop 0
    buffer_load_dwordx4 v33, s[32:35], s65 offen offset:0 sc1 lds
    buffer_load_dwordx4 v33, s[32:35], s65 offen offset:1024 sc1 lds
    buffer_load_dwordx4 v33, s[32:35], s65 offen offset:2048 sc1 lds
    buffer_load_dwordx4 v33, s[32:35], s65 offen offset:3072 sc1 lds
    s_add_u32 m0, s70, 24576
    s_nop 0
    buffer_load_dwordx4 v34, s[32:35], s65 offen offset:0 sc1 lds
    buffer_load_dwordx4 v34, s[32:35], s65 offen offset:1024 sc1 lds
    buffer_load_dwordx4 v34, s[32:35], s65 offen offset:2048 sc1 lds
    buffer_load_dwordx4 v34, s[32:35], s65 offen offset:3072 sc1 lds
    s_add_u32 m0, s70, 28672
    s_nop 0
    buffer_load_dwordx4 v35, s[32:35], s65 offen offset:0 sc1 lds
    buffer_load_dwordx4 v35, s[32:35], s65 offen offset:1024 sc1 lds
    s_add_u32 s65, s65, 14336
    s_cmp_ge_u32 s65, s63
    s_cselect_b32 s65, s64, s65
    s_add_u32 s70, s70, 30720
    s_cmp_ge_u32 s70, 153600
    s_cselect_b32 s70, 0, s70
    s_add_u32 s71, s71, 1
    s_cmp_lt_u32 s71, 27
    s_cbranch_scc1 BL_LOOP
    s_waitcnt vmcnt(42)
    s_barrier
    s_waitcnt vmcnt(28)
    s_barrier
    s_waitcnt vmcnt(14)
    s_barrier
    s_lshl_b32 s40, s58, 3
    s_lshr_b32 s41, s59, 2
    s_add_u32 s40, s40, s41
    s_and_b32 s41, s59, 3
    s_mul_i32 s42, s41, 196
    s_mul_i32 s43, s3, 7
    s_add_u32 s42, s42, s43
    s_lshl_b32 s42, s42, 10
    s_add_u32 s42, s42, 20971520
    v_lshlrev_b32 v14, 4, v2
    s_add_u32 s43, s42, 0
    buffer_load_dwordx4 v[144:147], v14, s[32:35], s43 offen offset:0 sc1
    buffer_load_dwordx4 v[148:151], v14, s[32:35], s43 offen offset:1024 sc1
    buffer_load_dwordx4 v[152:155], v14, s[32:35], s43 offen offset:2048 sc1
    buffer_load_dwordx4 v[156:159], v14, s[32:35], s43 offen offset:3072 sc1
    s_add_u32 s43, s42, 4096
    buffer_load_dwordx4 v[160:163], v14, s[32:35], s43 offen offset:0 sc1
    buffer_load_dwordx4 v[164:167], v14, s[32:35], s43 offen offset:1024 sc1
    buffer_load_dwordx4 v[168:171], v14, s[32:35], s43 offen offset:2048 sc1
    s_add_u32 s43, s42, 50176
    buffer_load_dwordx4 v[172:175], v14, s[32:35], s43 offen offset:0 sc1
    buffer_load_dwordx4 v[176:179], v14, s[32:35], s43 offen offset:1024 sc1
    buffer_load_dwordx4 v[180:183], v14, s[32:35], s43 offen offset:2048 sc1
    buffer_load_dwordx4 v[184:187], v14, s[32:35], s43 offen offset:3072 sc1
    s_add_u32 s43, s42, 54272
    buffer_load_dwordx4 v[188:191], v14, s[32:35], s43 offen offset:0 sc1
    buffer_load_dwordx4 v[192:195], v14, s[32:35], s43 offen offset:1024 sc1
    buffer_load_dwordx4 v[196:199], v14, s[32:35], s43 offen offset:2048 sc1
    s_add_u32 s43, s42, 100352
    buffer_load_dwordx4 v[200:203], v14, s[32:35], s43 offen offset:0 sc1
    buffer_load_dwordx4 v[204:207], v14, s[32:35], s43 offen offset:1024 sc1
    buffer_load_dwordx4 v[208:211], v14, s[32:35], s43 offen offset:2048 sc1
    buffer_load_dwordx4 v[212:215], v14, s[32:35], s43 offen offset:3072 sc1
    s_add_u32 s43, s42, 104448
    buffer_load_dwordx4 v[216:219], v14, s[32:35], s43 offen offset:0 sc1
    buffer_load_dwordx4 v[220:223], v14, s[32:35], s43 offen offset:1024 sc1
    buffer_load_dwordx4 v[224:227], v14, s[32:35], s43 offen offset:2048 sc1
    s_add_u32 s43, s42, 150528
    buffer_load_dwordx4 v[228:231], v14, s[32:35], s43 offen offset:0 sc1
    buffer_load_dwordx4 v[232:235], v14, s[32:35], s43 offen offset:1024 sc1
    buffer_load_dwordx4 v[236:239], v14, s[32:35], s43 offen offset:2048 sc1
    buffer_load_dwordx4 v[240:243], v14, s[32:35], s43 offen offset:3072 sc1
    s_add_u32 s43, s42, 154624
    buffer_load_dwordx4 v[244:247], v14, s[32:35], s43 offen offset:0 sc1
    buffer_load_dwordx4 v[248:251], v14, s[32:35], s43 offen offset:1024 sc1
    buffer_load_dwordx4 v[252:255], v14, s[32:35], s43 offen offset:2048 sc1
    s_waitcnt vmcnt(28)
    s_barrier
    s_waitcnt vmcnt(28)
    s_barrier
    s_branch P3
KF_AUX:
    v_lshlrev_b32 v14, 4, v2
    v_lshlrev_b32 v1, 2, v2
    v_mov_b32 v160, 0
    v_mov_b32 v161, 0
    v_mov_b32 v162, 0
    v_mov_b32 v163, 0
    s_and_b32 s77, s58, 3
    s_lshl_b32 s77, s77, 5
    s_add_u32 s77, s77, s59
    v_lshrrev_b32 v3, 2, v2
    v_and_b32 v4, 3, v2
    v_lshlrev_b32 v4, 7, v4
    v_lshl_add_u32 v12, v3, 12, v4
    v_lshrrev_b32 v3, 1, v2
    v_and_b32 v4, 1, v2
    v_lshlrev_b32 v4, 7, v4
    v_lshl_add_u32 v3, v3, 12, v4
    v_lshlrev_b32 v13, 7, v2
    s_waitcnt lgkmcnt(0)
    s_mov_b32 s32, s30
    s_and_b32 s33, s31, 0xffff
    s_mov_b32 s34, 23068672
    s_mov_b32 s35, 0x20000
    s_mov_b32 s36, s28
    s_and_b32 s37, s29, 0xffff
    s_mov_b32 s38, 256
    s_mov_b32 s39, 0x20000
    s_cmp_lt_u32 s2, 16
    s_cbranch_scc0 AX_NOZ
    s_lshl_b32 s62, s2, 13
    s_add_u32 s62, s62, 22085632
    s_add_u32 s63, s62, 4096
    s_lshl_b32 s64, s2, 10
    s_add_u32 s64, s64, 22413312
    buffer_store_dwordx4 v[160:163], v14, s[32:35], s64 offen sc0 sc1
    buffer_store_dwordx4 v[160:163], v14, s[32:35], s62 offen offset:0 sc0 sc1
    buffer_store_dwordx4 v[160:163], v14, s[32:35], s62 offen offset:1024 sc0 sc1
    buffer_store_dwordx4 v[160:163], v14, s[32:35], s62 offen offset:2048 sc0 sc1
    buffer_store_dwordx4 v[160:163], v14, s[32:35], s62 offen offset:3072 sc0 sc1
    buffer_store_dwordx4 v[160:163], v14, s[32:35], s63 offen offset:0 sc0 sc1
    buffer_store_dwordx4 v[160:163], v14, s[32:35], s63 offen offset:1024 sc0 sc1
    buffer_store_dwordx4 v[160:163], v14, s[32:35], s63 offen offset:2048 sc0 sc1
    buffer_store_dwordx4 v[160:163], v14, s[32:35], s63 offen offset:3072 sc0 sc1
AX_NOZ:
    s_mov_b32 s40, s4
    s_and_b32 s41, s5, 0xffff
    s_mov_b32 s42, 1835008
    s_mov_b32 s43, 0x20000
    s_mov_b32 s44, s16
    s_and_b32 s45, s17, 0xffff
    s_mov_b32 s46, 1605632
    s_mov_b32 s47, 0x20000
    s_mov_b32 s48, s18
    s_and_b32 s49, s19, 0xffff
    s_mov_b32 s50, 8388608
    s_mov_b32 s51, 0x20000
    s_cmp_lt_u32 s58, 6
    s_cselect_b32 s60, s6, s8
    s_cselect_b32 s63, s7, s9
    s_cmp_lt_u32 s58, 4
    s_cselect_b32 s52, s18, s60
    s_cselect_b32 s63, s19, s63
    s_and_b32 s53, s63, 0xffff
    s_mov_b32 s54, 8388608
    s_mov_b32 s55, 0x20000
    s_lshl_b32 s73, s56, 7
    s_and_b32 s72, s57, 3
    s_lshl_b32 s72, s72, 5
    s_add_u32 s72, s72, s73
    s_lshl_b32 s72, s72, 12
    s_lshl_b32 s74, s57, 4
    s_add_u32 s73, s73, s74
    s_lshl_b32 s73, s73, 12
    s_lshl_b32 s74, s77, 16
    s_lshr_b32 s98, s99, 2
    s_lshl_b32 s98, s98, 9
    v_and_b32 v1, 60, v1
    s_cmp_lt_u32 s58, 4
    s_cbranch_scc1 AX_NOTI
    s_mul_i32 s66, s77, 12544
    s_add_u32 s67, s66, 8192
    s_mul_i32 s68, s77, 14336
    s_add_u32 s69, s68, 8192
    buffer_load_dword v15, v13, s[44:47], s66 offen
    buffer_load_dword v15, v13, s[40:43], s68 offen
    buffer_load_dword v15, v13, s[44:47], s67 offen
    buffer_load_dword v15, v13, s[40:43], s69 offen
AX_NOTI:
    s_barrier
    s_cmp_lt_u32 s2, 16
    s_cbranch_scc0 AX_NOZ2
    s_lshl_b32 s62, s2, 2
    v_mov_b32 v4, 1
    s_waitcnt vmcnt(0)
    s_mov_b64 exec, 1
    buffer_store_dword v4, v160, s[36:39], s62 offen sc0 sc1
    s_mov_b64 exec, -1
AX_NOZ2:
    s_cmp_lt_u32 s58, 4
    s_cbranch_scc0 AX_Y
    s_barrier
    s_barrier
    s_barrier
    s_barrier
    buffer_load_dword v4, v1, s[36:39], 0 offen sc1
    s_barrier
    s_waitcnt vmcnt(0)
    s_mov_b32 s78, 0
AX_Zsp:
    v_cmp_ne_u32 vcc, 0, v4
    s_cmp_eq_u64 vcc, -1
    s_cbranch_scc1 AX_ZDsp
    s_add_u32 s78, s78, 1
    s_cmp_ge_u32 s78, 0x40000
    s_cbranch_scc1 AX_ZDsp
    s_sleep 1
    buffer_load_dword v4, v1, s[36:39], 0 offen sc1
    s_waitcnt vmcnt(0)
    s_branch AX_Zsp
AX_ZDsp:
    s_barrier
    s_add_u32 s79, s98, 0
    s_and_b32 s79, s79, 4095
    s_add_u32 s79, s79, s73
    buffer_load_dword v15, v12, s[48:51], s79 offen
    s_barrier
    s_barrier
    s_add_u32 s79, s98, 512
    s_and_b32 s79, s79, 4095
    s_add_u32 s79, s79, s73
    buffer_load_dword v15, v12, s[48:51], s79 offen
    s_barrier
    s_barrier
    s_add_u32 s79, s98, 1024
    s_and_b32 s79, s79, 4095
    s_add_u32 s79, s79, s73
    buffer_load_dword v15, v12, s[48:51], s79 offen
    s_barrier
    s_add_u32 s79, s98, 1536
    s_and_b32 s79, s79, 4095
    s_add_u32 s79, s79, s73
    buffer_load_dword v15, v12, s[48:51], s79 offen
    s_barrier
    s_add_u32 s79, s98, 2048
    s_and_b32 s79, s79, 4095
    s_add_u32 s79, s79, s73
    buffer_load_dword v15, v12, s[48:51], s79 offen
    s_barrier
    s_add_u32 s79, s98, 2560
    s_and_b32 s79, s79, 4095
    s_add_u32 s79, s79, s73
    buffer_load_dword v15, v12, s[48:51], s79 offen
    s_barrier
    s_add_u32 s79, s98, 3072
    s_and_b32 s79, s79, 4095
    s_add_u32 s79, s79, s73
    buffer_load_dword v15, v12, s[48:51], s79 offen
    s_barrier
    s_add_u32 s79, s98, 3584
    s_and_b32 s79, s79, 4095
    s_add_u32 s79, s79, s73
    buffer_load_dword v15, v12, s[48:51], s79 offen
    s_barrier
    s_barrier
    s_barrier
    s_barrier
    s_barrier
    s_barrier
    s_barrier
    s_barrier
    s_barrier
    s_barrier
    s_barrier
    s_barrier
    s_barrier
    s_barrier
    s_barrier
    s_barrier
    s_barrier
    s_barrier
    s_barrier
    s_barrier
    s_barrier
    v_lshrrev_b32 v4, 2, v2
    v_and_b32 v5, 3, v2
    v_lshlrev_b32 v5, 3, v5
    v_lshl_add_u32 v5, v4, 10, v5
    s_mov_b32 s75, 22413824
    buffer_load_dwordx2 v[6:7], v5, s[32:35], s75 offen sc1
    s_barrier
    s_barrier
    s_barrier
    s_barrier
    s_mov_b32 s78, 0
    s_waitcnt vmcnt(0)
AX_Wsp:
    v_min_u32 v6, v6, v7
    v_cmp_ne_u32 vcc, 0, v6
    s_cmp_eq_u64 vcc, -1
    s_cbranch_scc1 AX_WDsp
    s_add_u32 s78, s78, 1
    s_cmp_ge_u32 s78, 0x40000
    s_cbranch_scc1 AX_WDsp
    s_sleep 1
    buffer_load_dwordx2 v[6:7], v5, s[32:35], s75 offen sc1
    s_waitcnt vmcnt(0)
    s_branch AX_Wsp
AX_WDsp:
    s_barrier
    s_barrier
    s_barrier
    s_barrier
    s_lshl_b32 s40, s58, 3
    s_lshr_b32 s41, s59, 2
    s_add_u32 s40, s40, s41
    s_and_b32 s41, s59, 3
    s_mul_i32 s42, s41, 196
    s_mul_i32 s43, s3, 7
    s_add_u32 s42, s42, s43
    s_lshl_b32 s42, s42, 10
    s_add_u32 s42, s42, 20971520
    v_lshlrev_b32 v14, 4, v2
    s_add_u32 s43, s42, 0
    buffer_load_dwordx4 v[144:147], v14, s[32:35], s43 offen offset:0 sc1
    buffer_load_dwordx4 v[148:151], v14, s[32:35], s43 offen offset:1024 sc1
    buffer_load_dwordx4 v[152:155], v14, s[32:35], s43 offen offset:2048 sc1
    buffer_load_dwordx4 v[156:159], v14, s[32:35], s43 offen offset:3072 sc1
    s_add_u32 s43, s42, 4096
    buffer_load_dwordx4 v[160:163], v14, s[32:35], s43 offen offset:0 sc1
    buffer_load_dwordx4 v[164:167], v14, s[32:35], s43 offen offset:1024 sc1
    buffer_load_dwordx4 v[168:171], v14, s[32:35], s43 offen offset:2048 sc1
    s_add_u32 s43, s42, 50176
    buffer_load_dwordx4 v[172:175], v14, s[32:35], s43 offen offset:0 sc1
    buffer_load_dwordx4 v[176:179], v14, s[32:35], s43 offen offset:1024 sc1
    buffer_load_dwordx4 v[180:183], v14, s[32:35], s43 offen offset:2048 sc1
    buffer_load_dwordx4 v[184:187], v14, s[32:35], s43 offen offset:3072 sc1
    s_add_u32 s43, s42, 54272
    buffer_load_dwordx4 v[188:191], v14, s[32:35], s43 offen offset:0 sc1
    buffer_load_dwordx4 v[192:195], v14, s[32:35], s43 offen offset:1024 sc1
    buffer_load_dwordx4 v[196:199], v14, s[32:35], s43 offen offset:2048 sc1
    s_add_u32 s43, s42, 100352
    buffer_load_dwordx4 v[200:203], v14, s[32:35], s43 offen offset:0 sc1
    buffer_load_dwordx4 v[204:207], v14, s[32:35], s43 offen offset:1024 sc1
    buffer_load_dwordx4 v[208:211], v14, s[32:35], s43 offen offset:2048 sc1
    buffer_load_dwordx4 v[212:215], v14, s[32:35], s43 offen offset:3072 sc1
    s_add_u32 s43, s42, 104448
    buffer_load_dwordx4 v[216:219], v14, s[32:35], s43 offen offset:0 sc1
    buffer_load_dwordx4 v[220:223], v14, s[32:35], s43 offen offset:1024 sc1
    buffer_load_dwordx4 v[224:227], v14, s[32:35], s43 offen offset:2048 sc1
    s_add_u32 s43, s42, 150528
    buffer_load_dwordx4 v[228:231], v14, s[32:35], s43 offen offset:0 sc1
    buffer_load_dwordx4 v[232:235], v14, s[32:35], s43 offen offset:1024 sc1
    buffer_load_dwordx4 v[236:239], v14, s[32:35], s43 offen offset:2048 sc1
    buffer_load_dwordx4 v[240:243], v14, s[32:35], s43 offen offset:3072 sc1
    s_add_u32 s43, s42, 154624
    buffer_load_dwordx4 v[244:247], v14, s[32:35], s43 offen offset:0 sc1
    buffer_load_dwordx4 v[248:251], v14, s[32:35], s43 offen offset:1024 sc1
    buffer_load_dwordx4 v[252:255], v14, s[32:35], s43 offen offset:2048 sc1
    s_barrier
    s_barrier
    s_barrier
    s_branch AX_E
AX_Y:
    v_lshrrev_b32 v3, 2, v2
    v_and_b32 v4, 3, v2
    v_lshlrev_b32 v4, 7, v4
    v_lshl_add_u32 v3, v3, 12, v4
    s_barrier
    v_lshrrev_b32 v5, 3, v2
    v_and_b32 v6, 7, v2
    v_lshlrev_b32 v6, 4, v6
    v_mul_u32_u24 v7, 896, v5
    v_add_u32 v7, v7, v6
    s_mul_i32 s61, s77, 14336
    s_add_u32 s62, s61, 7168
    s_mov_b32 s44, s24
    s_and_b32 s45, s25, 0xffff
    s_mov_b32 s46, 896
    s_mov_b32 s47, 0x20000
    buffer_load_dwordx4 v[16:19], v7, s[40:43], s61 offen offset:0
    buffer_load_dwordx4 v[44:47], v7, s[40:43], s62 offen offset:0
    buffer_load_dwordx4 v[72:75], v6, s[44:47], 0 offen offset:0
    buffer_load_dwordx4 v[20:23], v7, s[40:43], s61 offen offset:128
    buffer_load_dwordx4 v[48:51], v7, s[40:43], s62 offen offset:128
    buffer_load_dwordx4 v[76:79], v6, s[44:47], 0 offen offset:128
    buffer_load_dwordx4 v[24:27], v7, s[40:43], s61 offen offset:256
    buffer_load_dwordx4 v[52:55], v7, s[40:43], s62 offen offset:256
    s_add_u32 s79, s72, 512
    buffer_load_dword v15, v3, s[52:55], s79 offen
    s_barrier
    buffer_load_dwordx4 v[80:83], v6, s[44:47], 0 offen offset:256
    buffer_load_dwordx4 v[28:31], v7, s[40:43], s61 offen offset:384
    buffer_load_dwordx4 v[56:59], v7, s[40:43], s62 offen offset:384
    buffer_load_dwordx4 v[84:87], v6, s[44:47], 0 offen offset:384
    buffer_load_dwordx4 v[32:35], v7, s[40:43], s61 offen offset:512
    buffer_load_dwordx4 v[60:63], v7, s[40:43], s62 offen offset:512
    buffer_load_dwordx4 v[88:91], v6, s[44:47], 0 offen offset:512
    buffer_load_dwordx4 v[36:39], v7, s[40:43], s61 offen offset:640
    s_barrier
    buffer_load_dwordx4 v[64:67], v7, s[40:43], s62 offen offset:640
    buffer_load_dwordx4 v[92:95], v6, s[44:47], 0 offen offset:640
    buffer_load_dwordx4 v[40:43], v7, s[40:43], s61 offen offset:768
    buffer_load_dwordx4 v[68:71], v7, s[40:43], s62 offen offset:768
    buffer_load_dwordx4 v[96:99], v6, s[44:47], 0 offen offset:768
    s_mov_b32 s44, s22
    s_and_b32 s45, s23, 0xffff
    s_mov_b32 s46, 802816
    s_mov_b32 s47, 0x20000
    v_and_b32 v8, 15, v2
    v_and_b32 v9, 12, v8
    v_and_b32 v10, 3, v8
    v_lshl_or_b32 v9, v9, 1, v10
    v_lshrrev_b32 v10, 4, v2
    v_mul_u32_u24 v10, 3584, v10
    v_lshl_add_u32 v8, v8, 1, v10
    v_lshl_add_u32 v9, v9, 1, v10
    s_min_u32 s62, s77, 111
    s_mul_i32 s63, s62, 2341
    s_lshr_b32 s63, s63, 16
    s_mul_i32 s64, s63, 28
    s_sub_u32 s65, s62, s64
    s_mul_i32 s67, s65, 9363
    s_lshr_b32 s67, s67, 16
    s_mul_i32 s68, s67, 7
    s_sub_u32 s68, s65, s68
    s_mul_i32 s67, s67, 224
    s_lshl_b32 s69, s68, 5
    s_cmp_ge_u32 s68, 3
    s_cselect_b32 s70, 16, 0
    s_add_u32 s69, s69, s70
    s_add_u32 s70, s69, 16
    s_cmp_eq_u32 s68, 6
    s_cselect_b32 s69, 96, s69
    s_cselect_b32 s70, 208, s70
    s_add_u32 s69, s69, s67
    s_add_u32 s70, s70, s67
    s_mul_i32 s69, s69, 896
    s_mul_i32 s70, s70, 896
    s_mul_i32 s71, s63, 224
    s_add_u32 s69, s69, s71
    s_add_u32 s70, s70, s71
    buffer_load_ushort v100, v9, s[44:47], s69 offen offset:0
    buffer_load_ushort v101, v9, s[44:47], s69 offen offset:896
    buffer_load_ushort v102, v9, s[44:47], s69 offen offset:1792
    s_add_u32 s79, s72, 66048
    buffer_load_dword v15, v3, s[52:55], s79 offen
    s_barrier
    buffer_load_ushort v103, v9, s[44:47], s69 offen offset:2688
    buffer_load_ushort v104, v9, s[44:47], s70 offen offset:0
    buffer_load_ushort v105, v9, s[44:47], s70 offen offset:896
    buffer_load_ushort v106, v9, s[44:47], s70 offen offset:1792
    buffer_load_ushort v107, v9, s[44:47], s70 offen offset:2688
    buffer_load_ushort v108, v9, s[44:47], s69 offen offset:8
    buffer_load_ushort v109, v9, s[44:47], s69 offen offset:904
    buffer_load_ushort v110, v9, s[44:47], s69 offen offset:1800
    buffer_load_dword v4, v1, s[36:39], 0 offen sc1
    s_barrier
    buffer_load_ushort v111, v9, s[44:47], s69 offen offset:2696
    buffer_load_ushort v112, v9, s[44:47], s70 offen offset:8
    buffer_load_ushort v113, v9, s[44:47], s70 offen offset:904
    buffer_load_ushort v114, v9, s[44:47], s70 offen offset:1800
    buffer_load_ushort v115, v9, s[44:47], s70 offen offset:2696
    buffer_load_ushort v116, v9, s[44:47], s69 offen offset:64
    buffer_load_ushort v117, v9, s[44:47], s69 offen offset:960
    buffer_load_ushort v118, v9, s[44:47], s69 offen offset:1856
    s_add_u32 s79, s72, 1024
    buffer_load_dword v15, v3, s[52:55], s79 offen
    s_waitcnt vmcnt(9)
    s_mov_b32 s78, 0
AX_Zy:
    v_cmp_ne_u32 vcc, 0, v4
    s_cmp_eq_u64 vcc, -1
    s_cbranch_scc1 AX_ZDy
    s_add_u32 s78, s78, 1
    s_cmp_ge_u32 s78, 0x40000
    s_cbranch_scc1 AX_ZDy
    s_sleep 1
    buffer_load_dword v4, v1, s[36:39], 0 offen sc1
    s_waitcnt vmcnt(0)
    s_branch AX_Zy
AX_ZDy:
    s_barrier
    buffer_load_ushort v119, v9, s[44:47], s69 offen offset:2752
    buffer_load_ushort v120, v9, s[44:47], s70 offen offset:64
    buffer_load_ushort v121, v9, s[44:47], s70 offen offset:960
    buffer_load_ushort v122, v9, s[44:47], s70 offen offset:1856
    buffer_load_ushort v123, v9, s[44:47], s70 offen offset:2752
    buffer_load_ushort v124, v9, s[44:47], s69 offen offset:72
    buffer_load_ushort v125, v9, s[44:47], s69 offen offset:968
    buffer_load_ushort v126, v9, s[44:47], s69 offen offset:1864
    s_barrier
    buffer_load_ushort v127, v9, s[44:47], s69 offen offset:2760
    buffer_load_ushort v128, v9, s[44:47], s70 offen offset:72
    buffer_load_ushort v129, v9, s[44:47], s70 offen offset:968
    buffer_load_ushort v130, v9, s[44:47], s70 offen offset:1864
    buffer_load_ushort v131, v9, s[44:47], s70 offen offset:2760
    buffer_load_ushort v132, v9, s[44:47], s69 offen offset:128
    buffer_load_ushort v133, v9, s[44:47], s69 offen offset:1024
    buffer_load_ushort v134, v9, s[44:47], s69 offen offset:1920
    s_add_u32 s79, s72, 66560
    buffer_load_dword v15, v3, s[52:55], s79 offen
    s_barrier
    buffer_load_ushort v135, v9, s[44:47], s69 offen offset:2816
    buffer_load_ushort v136, v9, s[44:47], s70 offen offset:128
    buffer_load_ushort v137, v9, s[44:47], s70 offen offset:1024
    buffer_load_ushort v138, v9, s[44:47], s70 offen offset:1920
    buffer_load_ushort v139, v9, s[44:47], s70 offen offset:2816
    buffer_load_ushort v140, v9, s[44:47], s69 offen offset:136
    buffer_load_ushort v141, v9, s[44:47], s69 offen offset:1032
    buffer_load_ushort v142, v9, s[44:47], s69 offen offset:1928
    s_barrier
    buffer_load_ushort v143, v9, s[44:47], s69 offen offset:2824
    buffer_load_ushort v144, v9, s[44:47], s70 offen offset:136
    buffer_load_ushort v145, v9, s[44:47], s70 offen offset:1032
    buffer_load_ushort v146, v9, s[44:47], s70 offen offset:1928
    buffer_load_ushort v147, v9, s[44:47], s70 offen offset:2824
    buffer_load_ushort v148, v8, s[44:47], s69 offen offset:192
    buffer_load_ushort v149, v8, s[44:47], s69 offen offset:1088
    buffer_load_ushort v150, v8, s[44:47], s69 offen offset:1984
    s_add_u32 s79, s72, 1536
    buffer_load_dword v15, v3, s[52:55], s79 offen
    s_barrier
    buffer_load_ushort v151, v8, s[44:47], s69 offen offset:2880
    buffer_load_ushort v152, v8, s[44:47], s70 offen offset:192
    buffer_load_ushort v153, v8, s[44:47], s70 offen offset:1088
    buffer_load_ushort v154, v8, s[44:47], s70 offen offset:1984
    buffer_load_ushort v155, v8, s[44:47], s70 offen offset:2880
    s_barrier
    s_add_u32 s79, s72, 67072
    buffer_load_dword v15, v3, s[52:55], s79 offen
    s_barrier
    s_barrier
    s_add_u32 s79, s72, 2048
    buffer_load_dword v15, v3, s[52:55], s79 offen
    s_barrier
    s_waitcnt vmcnt(2)
    v_mov_b32 v10, 0
    v_mov_b32 v11, 0
    v_dot2_f32_bf16 v10, v16, v72, v10
    v_dot2_f32_bf16 v11, v44, v72, v11
    v_dot2_f32_bf16 v10, v17, v73, v10
    v_dot2_f32_bf16 v11, v45, v73, v11
    v_dot2_f32_bf16 v10, v18, v74, v10
    v_dot2_f32_bf16 v11, v46, v74, v11
    v_dot2_f32_bf16 v10, v19, v75, v10
    v_dot2_f32_bf16 v11, v47, v75, v11
    v_dot2_f32_bf16 v10, v20, v76, v10
    v_dot2_f32_bf16 v11, v48, v76, v11
    v_dot2_f32_bf16 v10, v21, v77, v10
    v_dot2_f32_bf16 v11, v49, v77, v11
    v_dot2_f32_bf16 v10, v22, v78, v10
    v_dot2_f32_bf16 v11, v50, v78, v11
    v_dot2_f32_bf16 v10, v23, v79, v10
    v_dot2_f32_bf16 v11, v51, v79, v11
    v_dot2_f32_bf16 v10, v24, v80, v10
    v_dot2_f32_bf16 v11, v52, v80, v11
    v_dot2_f32_bf16 v10, v25, v81, v10
    v_dot2_f32_bf16 v11, v53, v81, v11
    v_dot2_f32_bf16 v10, v26, v82, v10
    v_dot2_f32_bf16 v11, v54, v82, v11
    v_dot2_f32_bf16 v10, v27, v83, v10
    v_dot2_f32_bf16 v11, v55, v83, v11
    v_dot2_f32_bf16 v10, v28, v84, v10
    v_dot2_f32_bf16 v11, v56, v84, v11
    v_dot2_f32_bf16 v10, v29, v85, v10
    v_dot2_f32_bf16 v11, v57, v85, v11
    v_dot2_f32_bf16 v10, v30, v86, v10
    v_dot2_f32_bf16 v11, v58, v86, v11
    v_dot2_f32_bf16 v10, v31, v87, v10
    v_dot2_f32_bf16 v11, v59, v87, v11
    v_dot2_f32_bf16 v10, v32, v88, v10
    v_dot2_f32_bf16 v11, v60, v88, v11
    v_dot2_f32_bf16 v10, v33, v89, v10
    v_dot2_f32_bf16 v11, v61, v89, v11
    v_dot2_f32_bf16 v10, v34, v90, v10
    v_dot2_f32_bf16 v11, v62, v90, v11
    v_dot2_f32_bf16 v10, v35, v91, v10
    v_dot2_f32_bf16 v11, v63, v91, v11
    v_dot2_f32_bf16 v10, v36, v92, v10
    v_dot2_f32_bf16 v11, v64, v92, v11
    v_dot2_f32_bf16 v10, v37, v93, v10
    v_dot2_f32_bf16 v11, v65, v93, v11
    v_dot2_f32_bf16 v10, v38, v94, v10
    v_dot2_f32_bf16 v11, v66, v94, v11
    v_dot2_f32_bf16 v10, v39, v95, v10
    v_dot2_f32_bf16 v11, v67, v95, v11
    v_dot2_f32_bf16 v10, v40, v96, v10
    v_dot2_f32_bf16 v11, v68, v96, v11
    v_dot2_f32_bf16 v10, v41, v97, v10
    v_dot2_f32_bf16 v11, v69, v97, v11
    v_dot2_f32_bf16 v10, v42, v98, v10
    v_dot2_f32_bf16 v11, v70, v98, v11
    v_dot2_f32_bf16 v10, v43, v99, v10
    v_dot2_f32_bf16 v11, v71, v99, v11
    s_nop 3
    v_add_f32_dpp v10, v10, v10 quad_perm:[1,0,3,2] row_mask:0xf bank_mask:0xf
    v_add_f32_dpp v11, v11, v11 quad_perm:[1,0,3,2] row_mask:0xf bank_mask:0xf
    s_nop 1
    v_add_f32_dpp v10, v10, v10 quad_perm:[2,3,0,1] row_mask:0xf bank_mask:0xf
    v_add_f32_dpp v11, v11, v11 quad_perm:[2,3,0,1] row_mask:0xf bank_mask:0xf
    s_nop 1
    v_add_f32_dpp v10, v10, v10 row_half_mirror row_mask:0xf bank_mask:0xf
    v_add_f32_dpp v11, v11, v11 row_half_mirror row_mask:0xf bank_mask:0xf
    s_nop 1
    v_mul_f32 v10, 0xbfb8aa3b, v10
    v_mul_f32 v11, 0xbfb8aa3b, v11
    v_exp_f32 v10, v10
    v_exp_f32 v11, v11
    s_lshl_b32 s75, s77, 6
    v_add_f32 v10, 1.0, v10
    v_add_f32 v11, 1.0, v11
    v_rcp_f32 v10, v10
    v_rcp_f32 v11, v11
    s_add_u32 s75, s75, 22020096
    v_lshlrev_b32 v5, 2, v5
    s_mov_b32 exec_lo, 0x01010101
    s_mov_b32 exec_hi, 0x01010101
    buffer_store_dword v10, v5, s[32:35], s75 offen offset:0 sc0 sc1
    buffer_store_dword v11, v5, s[32:35], s75 offen offset:32 sc0 sc1
    s_mov_b64 exec, -1
    s_barrier
    s_add_u32 s79, s72, 67584
    buffer_load_dword v15, v3, s[52:55], s79 offen
    s_mul_i32 s75, s62, 7168
    s_add_u32 s75, s75, 20971520
    s_add_u32 s76, s75, 4096
    v_lshl_or_b32 v16, v101, 16, v100
    v_lshl_or_b32 v17, v103, 16, v102
    v_lshl_or_b32 v18, v105, 16, v104
    v_lshl_or_b32 v19, v107, 16, v106
    v_lshl_or_b32 v20, v109, 16, v108
    v_lshl_or_b32 v21, v111, 16, v110
    v_lshl_or_b32 v22, v113, 16, v112
    v_lshl_or_b32 v23, v115, 16, v114
    v_lshl_or_b32 v24, v117, 16, v116
    v_lshl_or_b32 v25, v119, 16, v118
    v_lshl_or_b32 v26, v121, 16, v120
    v_lshl_or_b32 v27, v123, 16, v122
    v_lshl_or_b32 v28, v125, 16, v124
    v_lshl_or_b32 v29, v127, 16, v126
    v_lshl_or_b32 v30, v129, 16, v128
    v_lshl_or_b32 v31, v131, 16, v130
    v_lshl_or_b32 v32, v133, 16, v132
    v_lshl_or_b32 v33, v135, 16, v134
    v_lshl_or_b32 v34, v137, 16, v136
    v_lshl_or_b32 v35, v139, 16, v138
    v_lshl_or_b32 v36, v141, 16, v140
    v_lshl_or_b32 v37, v143, 16, v142
    v_lshl_or_b32 v38, v145, 16, v144
    v_lshl_or_b32 v39, v147, 16, v146
    v_lshl_or_b32 v40, v149, 16, v148
    v_lshl_or_b32 v41, v151, 16, v150
    v_lshl_or_b32 v42, v153, 16, v152
    v_lshl_or_b32 v43, v155, 16, v154
    buffer_store_dwordx4 v[16:19], v14, s[32:35], s75 offen offset:0 sc0 sc1
    buffer_store_dwordx4 v[20:23], v14, s[32:35], s75 offen offset:1024 sc0 sc1
    buffer_store_dwordx4 v[24:27], v14, s[32:35], s75 offen offset:2048 sc0 sc1
    buffer_store_dwordx4 v[28:31], v14, s[32:35], s75 offen offset:3072 sc0 sc1
    buffer_store_dwordx4 v[32:35], v14, s[32:35], s76 offen offset:0 sc0 sc1
    buffer_store_dwordx4 v[36:39], v14, s[32:35], s76 offen offset:1024 sc0 sc1
    buffer_store_dwordx4 v[40:43], v14, s[32:35], s76 offen offset:2048 sc0 sc1
    s_lshl_b32 s79, s77, 10
    s_add_u32 s79, s79, 22249472
    buffer_store_dwordx4 v[160:163], v14, s[32:35], s79 offen sc0 sc1
    s_barrier
    s_barrier
    s_add_u32 s79, s72, 2560
    buffer_load_dword v15, v3, s[52:55], s79 offen
    s_barrier
    s_lshr_b32 s75, s77, 3
    s_lshl_b32 s75, s75, 10
    s_and_b32 s76, s77, 7
    s_lshl_b32 s76, s76, 2
    s_add_u32 s75, s75, s76
    s_add_u32 s75, s75, 22413824
    v_mov_b32 v4, 1
    s_waitcnt vmcnt(1)
    s_mov_b64 exec, 1
    buffer_store_dword v4, v160, s[32:35], s75 offen sc0 sc1
    s_mov_b64 exec, -1
    s_barrier
    s_add_u32 s79, s72, 68096
    buffer_load_dword v15, v3, s[52:55], s79 offen
    s_barrier
    s_barrier
    s_add_u32 s79, s72, 3072
    buffer_load_dword v15, v3, s[52:55], s79 offen
    s_barrier
    s_barrier
    s_add_u32 s79, s72, 68608
    buffer_load_dword v15, v3, s[52:55], s79 offen
    s_barrier
    s_barrier
    s_add_u32 s79, s72, 3584
    buffer_load_dword v15, v3, s[52:55], s79 offen
    s_barrier
    s_barrier
    s_add_u32 s79, s72, 69120
    buffer_load_dword v15, v3, s[52:55], s79 offen
    s_barrier
    s_barrier
    v_lshrrev_b32 v4, 2, v2
    v_and_b32 v5, 3, v2
    v_lshlrev_b32 v5, 3, v5
    v_lshl_add_u32 v5, v4, 10, v5
    s_mov_b32 s75, 22413824
    buffer_load_dwordx2 v[6:7], v5, s[32:35], s75 offen sc1
    s_barrier
    s_barrier
    s_barrier
    s_barrier
    s_mov_b32 s78, 0
    s_waitcnt vmcnt(0)
AX_Wy:
    v_min_u32 v6, v6, v7
    v_cmp_ne_u32 vcc, 0, v6
    s_cmp_eq_u64 vcc, -1
    s_cbranch_scc1 AX_WDy
    s_add_u32 s78, s78, 1
    s_cmp_ge_u32 s78, 0x40000
    s_cbranch_scc1 AX_WDy
    s_sleep 1
    buffer_load_dwordx2 v[6:7], v5, s[32:35], s75 offen sc1
    s_waitcnt vmcnt(0)
    s_branch AX_Wy
AX_WDy:
    s_barrier
    s_barrier
    s_barrier
    s_barrier
    s_lshl_b32 s40, s58, 3
    s_lshr_b32 s41, s59, 2
    s_add_u32 s40, s40, s41
    s_and_b32 s41, s59, 3
    s_mul_i32 s42, s41, 196
    s_mul_i32 s43, s3, 7
    s_add_u32 s42, s42, s43
    s_lshl_b32 s42, s42, 10
    s_add_u32 s42, s42, 20971520
    v_lshlrev_b32 v14, 4, v2
    s_add_u32 s43, s42, 0
    buffer_load_dwordx4 v[144:147], v14, s[32:35], s43 offen offset:0 sc1
    buffer_load_dwordx4 v[148:151], v14, s[32:35], s43 offen offset:1024 sc1
    buffer_load_dwordx4 v[152:155], v14, s[32:35], s43 offen offset:2048 sc1
    buffer_load_dwordx4 v[156:159], v14, s[32:35], s43 offen offset:3072 sc1
    s_add_u32 s43, s42, 4096
    buffer_load_dwordx4 v[160:163], v14, s[32:35], s43 offen offset:0 sc1
    buffer_load_dwordx4 v[164:167], v14, s[32:35], s43 offen offset:1024 sc1
    buffer_load_dwordx4 v[168:171], v14, s[32:35], s43 offen offset:2048 sc1
    s_add_u32 s43, s42, 50176
    buffer_load_dwordx4 v[172:175], v14, s[32:35], s43 offen offset:0 sc1
    buffer_load_dwordx4 v[176:179], v14, s[32:35], s43 offen offset:1024 sc1
    buffer_load_dwordx4 v[180:183], v14, s[32:35], s43 offen offset:2048 sc1
    buffer_load_dwordx4 v[184:187], v14, s[32:35], s43 offen offset:3072 sc1
    s_add_u32 s43, s42, 54272
    buffer_load_dwordx4 v[188:191], v14, s[32:35], s43 offen offset:0 sc1
    buffer_load_dwordx4 v[192:195], v14, s[32:35], s43 offen offset:1024 sc1
    buffer_load_dwordx4 v[196:199], v14, s[32:35], s43 offen offset:2048 sc1
    s_add_u32 s43, s42, 100352
    buffer_load_dwordx4 v[200:203], v14, s[32:35], s43 offen offset:0 sc1
    buffer_load_dwordx4 v[204:207], v14, s[32:35], s43 offen offset:1024 sc1
    buffer_load_dwordx4 v[208:211], v14, s[32:35], s43 offen offset:2048 sc1
    buffer_load_dwordx4 v[212:215], v14, s[32:35], s43 offen offset:3072 sc1
    s_add_u32 s43, s42, 104448
    buffer_load_dwordx4 v[216:219], v14, s[32:35], s43 offen offset:0 sc1
    buffer_load_dwordx4 v[220:223], v14, s[32:35], s43 offen offset:1024 sc1
    buffer_load_dwordx4 v[224:227], v14, s[32:35], s43 offen offset:2048 sc1
    s_add_u32 s43, s42, 150528
    buffer_load_dwordx4 v[228:231], v14, s[32:35], s43 offen offset:0 sc1
    buffer_load_dwordx4 v[232:235], v14, s[32:35], s43 offen offset:1024 sc1
    buffer_load_dwordx4 v[236:239], v14, s[32:35], s43 offen offset:2048 sc1
    buffer_load_dwordx4 v[240:243], v14, s[32:35], s43 offen offset:3072 sc1
    s_add_u32 s43, s42, 154624
    buffer_load_dwordx4 v[244:247], v14, s[32:35], s43 offen offset:0 sc1
    buffer_load_dwordx4 v[248:251], v14, s[32:35], s43 offen offset:1024 sc1
    buffer_load_dwordx4 v[252:255], v14, s[32:35], s43 offen offset:2048 sc1
    s_barrier
    s_barrier
    s_barrier
AX_E:
    v_lshlrev_b32 v5, 13, v2
    s_lshl_b32 s75, s40, 7
    s_add_u32 s75, s75, 22249472
    s_lshl_b32 s76, 0x1100, s41
    s_or_b32 s76, s76, 0xff
    s_mov_b32 s77, 0
    s_mov_b64 exec, s[76:77]
    s_mov_b32 s78, 0
AX_P_POLL:
    buffer_load_dword v4, v5, s[32:35], s75 offen sc1
    s_waitcnt vmcnt(0)
    v_cmp_eq_u32 vcc, 0, v4
    s_cmp_eq_u64 vcc, 0
    s_cbranch_scc1 AX_P_GO
    s_mov_b64 exec, vcc
    s_add_u32 s78, s78, 1
    s_cmp_ge_u32 s78, 0x40000
    s_cbranch_scc1 AX_P_GO
    s_sleep 0
    s_branch AX_P_POLL
AX_P_GO:
    s_mov_b64 exec, -1
    s_branch P3
KF_COMPUTE:
    v_and_b32 v3, 15, v2
    v_lshrrev_b32 v4, 1, v3
    v_lshrrev_b32 v5, 4, v2
    v_xor_b32 v4, v4, v5
    v_lshlrev_b32 v4, 4, v4
    v_lshl_add_u32 v5, v3, 7, v4
    s_lshl_b32 s63, s3, 12
    v_add_u32 v6, s63, v5
    v_xor_b32 v7, 64, v6
    v_lshlrev_b32 v14, 4, v2
    v_add_u32 v8, 0x4000, v14
    v_lshlrev_b32 v15, 3, v2
    v_mov_b32 v9, v6
    s_lshl_b32 s64, s56, 3
    s_lshl_b32 s65, s3, 1
    s_add_u32 s64, s64, s65
    s_lshl_b32 s72, s56, 2
    s_add_u32 s72, s72, s3
    s_mul_i32 s73, s57, 458752
    s_mul_i32 s74, s72, 7168
    s_add_u32 s73, s73, s74
    s_add_u32 s77, s73, 4096
    s_lshl_b32 s74, s57, 10
    s_lshl_b32 s75, s72, 2
    s_add_u32 s74, s74, s75
    s_add_u32 s74, s74, 22413312
    s_lshl_b32 s75, s72, 11
    s_add_u32 s75, s75, 22085632
    s_lshl_b32 s76, s57, 8
    s_add_u32 s76, s76, s75
    v_mov_b32 v16, 0
    v_mov_b32 v17, 0
    v_mov_b32 v18, 0
    v_mov_b32 v19, 0
    v_mov_b32 v20, 0
    v_mov_b32 v21, 0
    v_mov_b32 v22, 0
    v_mov_b32 v23, 0
    v_mov_b32 v24, 0
    v_mov_b32 v25, 0
    v_mov_b32 v26, 0
    v_mov_b32 v27, 0
    v_mov_b32 v28, 0
    v_mov_b32 v29, 0
    v_mov_b32 v30, 0
    v_mov_b32 v31, 0
    v_mov_b32 v32, 0
    v_mov_b32 v33, 0
    v_mov_b32 v34, 0
    v_mov_b32 v35, 0
    v_mov_b32 v36, 0
    v_mov_b32 v37, 0
    v_mov_b32 v38, 0
    v_mov_b32 v39, 0
    v_mov_b32 v40, 0
    v_mov_b32 v41, 0
    v_mov_b32 v42, 0
    v_mov_b32 v43, 0
    v_mov_b32 v44, 0
    v_mov_b32 v45, 0
    v_mov_b32 v46, 0
    v_mov_b32 v47, 0
    v_mov_b32 v48, 0
    v_mov_b32 v49, 0
    v_mov_b32 v50, 0
    v_mov_b32 v51, 0
    v_mov_b32 v52, 0
    v_mov_b32 v53, 0
    v_mov_b32 v54, 0
    v_mov_b32 v55, 0
    v_mov_b32 v56, 0
    v_mov_b32 v57, 0
    v_mov_b32 v58, 0
    v_mov_b32 v59, 0
    v_mov_b32 v60, 0
    v_mov_b32 v61, 0
    v_mov_b32 v62, 0
    v_mov_b32 v63, 0
    v_mov_b32 v64, 0
    v_mov_b32 v65, 0
    v_mov_b32 v66, 0
    v_mov_b32 v67, 0
    v_mov_b32 v68, 0
    v_mov_b32 v69, 0
    v_mov_b32 v70, 0
    v_mov_b32 v71, 0
    s_mov_b32 s70, 0
    s_mov_b32 s71, 0
    s_cmp_lt_u32 s58, 4
    s_cbranch_scc0 C_Y
    v_lshrrev_b32 v3, 5, v2
    v_lshlrev_b32 v3, 4, v3
    v_bfe_u32 v4, v2, 4, 1
    v_lshl_add_u32 v3, v4, 2, v3
    v_bfe_u32 v4, v2, 2, 2
    v_add_u32 v3, v3, v4
    v_mul_u32_u24 v3, 224, v3
    v_and_b32 v4, 3, v2
    v_lshl_add_u32 v3, v4, 3, v3
    v_add_u32 v11, 0x4000, v3
    v_mov_b32 v10, v11
    v_mov_b32 v232, 0xbdd2d3e8
    v_mov_b32 v233, 0xbdd2d3e8
    v_mov_b32 v234, 0xc0135761
    v_mov_b32 v235, 0xc0135761
    v_mov_b32 v176, 0
    v_mov_b32 v177, 0
    v_mov_b32 v178, 0
    v_mov_b32 v179, 0
    v_mov_b32 v180, 0
    v_mov_b32 v181, 0
    v_mov_b32 v182, 0
    v_mov_b32 v183, 0
    v_mov_b32 v184, 0
    v_mov_b32 v185, 0
    v_mov_b32 v186, 0
    v_mov_b32 v187, 0
    v_mov_b32 v188, 0
    v_mov_b32 v189, 0
    v_mov_b32 v190, 0
    v_mov_b32 v191, 0
    v_mov_b32 v192, 0
    v_mov_b32 v193, 0
    v_mov_b32 v194, 0
    v_mov_b32 v195, 0
    v_mov_b32 v196, 0
    v_mov_b32 v197, 0
    v_mov_b32 v198, 0
    v_mov_b32 v199, 0
    v_mov_b32 v200, 0
    v_mov_b32 v201, 0
    v_mov_b32 v202, 0
    v_mov_b32 v203, 0
    v_mov_b32 v204, 0
    v_mov_b32 v205, 0
    v_mov_b32 v206, 0
    v_mov_b32 v207, 0
    v_mov_b32 v208, 0
    v_mov_b32 v209, 0
    v_mov_b32 v210, 0
    v_mov_b32 v211, 0
    v_mov_b32 v212, 0
    v_mov_b32 v213, 0
    v_mov_b32 v214, 0
    v_mov_b32 v215, 0
    v_mov_b32 v216, 0
    v_mov_b32 v217, 0
    v_mov_b32 v218, 0
    v_mov_b32 v219, 0
    v_mov_b32 v220, 0
    v_mov_b32 v221, 0
    v_mov_b32 v222, 0
    v_mov_b32 v223, 0
    v_mov_b32 v224, 0
    v_mov_b32 v225, 0
    v_mov_b32 v226, 0
    v_mov_b32 v227, 0
    v_mov_b32 v228, 0
    v_mov_b32 v229, 0
    v_mov_b32 v230, 0
    v_mov_b32 v231, 0
    v_and_b32 v4, 12, v2
    v_and_b32 v12, 3, v2
    v_lshl_or_b32 v4, v4, 1, v12
    v_lshlrev_b32 v4, 1, v4
    s_lshl_b32 s69, s64, 5
    s_lshl_b32 s66, s64, 3
    s_add_u32 s66, s66, s57
    s_mul_i32 s66, s66, 3584
    s_add_u32 s66, s66, 12582912
    s_add_u32 s67, s66, 28672
    s_waitcnt lgkmcnt(0)
    s_mov_b32 s32, s30
    s_and_b32 s33, s31, 0xffff
    s_mov_b32 s34, 23068672
    s_mov_b32 s35, 0x20000
    s_mov_b32 s36, s28
    s_and_b32 s37, s29, 0xffff
    s_mov_b32 s38, 256
    s_mov_b32 s39, 0x20000
    s_mov_b32 s44, s20
    s_and_b32 s45, s21, 0xffff
    s_mov_b32 s46, 4096
    s_mov_b32 s47, 0x20000
    buffer_load_ushort v172, v4, s[44:47], s69 offen
    buffer_load_ushort v173, v4, s[44:47], s69 offen offset:8
    s_barrier
    ds_read_b128 v[72:75], v9
    ds_read_b128 v[76:79], v9 offset:2048
    ds_read_b64_tr_b16 v[80:81], v10 offset:0
    ds_read_b64_tr_b16 v[82:83], v10 offset:1792
    ds_read_b64_tr_b16 v[84:85], v10 offset:32
    ds_read_b64_tr_b16 v[86:87], v10 offset:1824
    ds_read_b64_tr_b16 v[88:89], v10 offset:64
    ds_read_b64_tr_b16 v[90:91], v10 offset:1856
    ds_read_b64_tr_b16 v[92:93], v10 offset:96
    ds_read_b64_tr_b16 v[94:95], v10 offset:1888
    ds_read_b64_tr_b16 v[96:97], v10 offset:128
    ds_read_b64_tr_b16 v[98:99], v10 offset:1920
    ds_read_b64_tr_b16 v[100:101], v10 offset:160
    ds_read_b64_tr_b16 v[102:103], v10 offset:1952
    ds_read_b64_tr_b16 v[104:105], v10 offset:192
    ds_read_b64_tr_b16 v[106:107], v10 offset:1984
.p2align 6
C_Z2:
    v_add_u32 v12, s70, v7
    v_add_u32 v13, s70, v11
    s_add_u32 s70, s70, 30720
    s_cmp_ge_u32 s70, 153600
    s_cselect_b32 s70, 0, s70
    s_waitcnt lgkmcnt(0)
    ds_read_b128 v[108:111], v12
    ds_read_b128 v[112:115], v12 offset:2048
    v_mfma_f32_16x16x32_bf16 v[176:179], v[72:75], v[80:83], v[176:179]
    ds_read_b64_tr_b16 v[116:117], v13 offset:7168
    v_mfma_f32_16x16x32_bf16 v[180:183], v[76:79], v[80:83], v[180:183]
    ds_read_b64_tr_b16 v[118:119], v13 offset:8960
    v_mfma_f32_16x16x32_bf16 v[184:187], v[72:75], v[84:87], v[184:187]
    ds_read_b64_tr_b16 v[120:121], v13 offset:7200
    v_mfma_f32_16x16x32_bf16 v[188:191], v[76:79], v[84:87], v[188:191]
    ds_read_b64_tr_b16 v[122:123], v13 offset:8992
    v_mfma_f32_16x16x32_bf16 v[192:195], v[72:75], v[88:91], v[192:195]
    ds_read_b64_tr_b16 v[124:125], v13 offset:7232
    v_mfma_f32_16x16x32_bf16 v[196:199], v[76:79], v[88:91], v[196:199]
    ds_read_b64_tr_b16 v[126:127], v13 offset:9024
    v_mfma_f32_16x16x32_bf16 v[200:203], v[72:75], v[92:95], v[200:203]
    ds_read_b64_tr_b16 v[128:129], v13 offset:7264
    v_mfma_f32_16x16x32_bf16 v[204:207], v[76:79], v[92:95], v[204:207]
    ds_read_b64_tr_b16 v[130:131], v13 offset:9056
    v_mfma_f32_16x16x32_bf16 v[208:211], v[72:75], v[96:99], v[208:211]
    ds_read_b64_tr_b16 v[132:133], v13 offset:7296
    v_mfma_f32_16x16x32_bf16 v[212:215], v[76:79], v[96:99], v[212:215]
    ds_read_b64_tr_b16 v[134:135], v13 offset:9088
    v_mfma_f32_16x16x32_bf16 v[216:219], v[72:75], v[100:103], v[216:219]
    ds_read_b64_tr_b16 v[136:137], v13 offset:7328
    v_mfma_f32_16x16x32_bf16 v[220:223], v[76:79], v[100:103], v[220:223]
    ds_read_b64_tr_b16 v[138:139], v13 offset:9120
    v_mfma_f32_16x16x32_bf16 v[224:227], v[72:75], v[104:107], v[224:227]
    ds_read_b64_tr_b16 v[140:141], v13 offset:7360
    v_mfma_f32_16x16x32_bf16 v[228:231], v[76:79], v[104:107], v[228:231]
    ds_read_b64_tr_b16 v[142:143], v13 offset:9152
    v_add_u32 v9, s70, v6
    v_add_u32 v10, s70, v11
    s_waitcnt lgkmcnt(0)
    s_barrier
    ds_read_b128 v[72:75], v9
    ds_read_b128 v[76:79], v9 offset:2048
    v_mfma_f32_16x16x32_bf16 v[176:179], v[108:111], v[116:119], v[176:179]
    ds_read_b64_tr_b16 v[80:81], v10 offset:0
    v_mfma_f32_16x16x32_bf16 v[180:183], v[112:115], v[116:119], v[180:183]
    ds_read_b64_tr_b16 v[82:83], v10 offset:1792
    v_mfma_f32_16x16x32_bf16 v[184:187], v[108:111], v[120:123], v[184:187]
    ds_read_b64_tr_b16 v[84:85], v10 offset:32
    v_mfma_f32_16x16x32_bf16 v[188:191], v[112:115], v[120:123], v[188:191]
    ds_read_b64_tr_b16 v[86:87], v10 offset:1824
    v_mfma_f32_16x16x32_bf16 v[192:195], v[108:111], v[124:127], v[192:195]
    ds_read_b64_tr_b16 v[88:89], v10 offset:64
    v_mfma_f32_16x16x32_bf16 v[196:199], v[112:115], v[124:127], v[196:199]
    ds_read_b64_tr_b16 v[90:91], v10 offset:1856
    v_mfma_f32_16x16x32_bf16 v[200:203], v[108:111], v[128:131], v[200:203]
    ds_read_b64_tr_b16 v[92:93], v10 offset:96
    v_mfma_f32_16x16x32_bf16 v[204:207], v[112:115], v[128:131], v[204:207]
    ds_read_b64_tr_b16 v[94:95], v10 offset:1888
    v_mfma_f32_16x16x32_bf16 v[208:211], v[108:111], v[132:135], v[208:211]
    ds_read_b64_tr_b16 v[96:97], v10 offset:128
    v_mfma_f32_16x16x32_bf16 v[212:215], v[112:115], v[132:135], v[212:215]
    ds_read_b64_tr_b16 v[98:99], v10 offset:1920
    v_mfma_f32_16x16x32_bf16 v[216:219], v[108:111], v[136:139], v[216:219]
    ds_read_b64_tr_b16 v[100:101], v10 offset:160
    v_mfma_f32_16x16x32_bf16 v[220:223], v[112:115], v[136:139], v[220:223]
    ds_read_b64_tr_b16 v[102:103], v10 offset:1952
    v_mfma_f32_16x16x32_bf16 v[224:227], v[108:111], v[140:143], v[224:227]
    ds_read_b64_tr_b16 v[104:105], v10 offset:192
    v_mfma_f32_16x16x32_bf16 v[228:231], v[112:115], v[140:143], v[228:231]
    ds_read_b64_tr_b16 v[106:107], v10 offset:1984
    s_add_u32 s71, s71, 1
    s_cmp_lt_u32 s71, 7
    s_cbranch_scc1 C_Z2
    s_nop 7
    v_pk_mul_f32 v[108:109], v[176:177], v[176:177]
    v_pk_mul_f32 v[110:111], v[178:179], v[178:179]
    v_pk_mul_f32 v[112:113], v[180:181], v[180:181]
    v_pk_mul_f32 v[114:115], v[182:183], v[182:183]
    v_pk_mul_f32 v[116:117], v[184:185], v[184:185]
    v_pk_mul_f32 v[118:119], v[186:187], v[186:187]
    v_pk_mul_f32 v[120:121], v[188:189], v[188:189]
    v_pk_mul_f32 v[122:123], v[190:191], v[190:191]
    v_pk_mul_f32 v[124:125], v[192:193], v[192:193]
    v_pk_mul_f32 v[126:127], v[194:195], v[194:195]
    v_pk_mul_f32 v[128:129], v[196:197], v[196:197]
    v_pk_mul_f32 v[130:131], v[198:199], v[198:199]
    v_pk_mul_f32 v[132:133], v[200:201], v[200:201]
    v_pk_mul_f32 v[134:135], v[202:203], v[202:203]
    v_pk_fma_f32 v[108:109], v[108:109], v[232:233], v[234:235]
    v_pk_fma_f32 v[110:111], v[110:111], v[232:233], v[234:235]
    v_pk_fma_f32 v[112:113], v[112:113], v[232:233], v[234:235]
    v_pk_fma_f32 v[114:115], v[114:115], v[232:233], v[234:235]
    v_pk_fma_f32 v[116:117], v[116:117], v[232:233], v[234:235]
    v_pk_fma_f32 v[118:119], v[118:119], v[232:233], v[234:235]
    v_pk_fma_f32 v[120:121], v[120:121], v[232:233], v[234:235]
    v_pk_fma_f32 v[122:123], v[122:123], v[232:233], v[234:235]
    v_pk_fma_f32 v[124:125], v[124:125], v[232:233], v[234:235]
    v_pk_fma_f32 v[126:127], v[126:127], v[232:233], v[234:235]
    v_pk_fma_f32 v[128:129], v[128:129], v[232:233], v[234:235]
    v_pk_fma_f32 v[130:131], v[130:131], v[232:233], v[234:235]
    v_pk_fma_f32 v[132:133], v[132:133], v[232:233], v[234:235]
    v_pk_fma_f32 v[134:135], v[134:135], v[232:233], v[234:235]
    v_pk_mul_f32 v[108:109], v[108:109], v[176:177]
    v_pk_mul_f32 v[110:111], v[110:111], v[178:179]
    v_pk_mul_f32 v[112:113], v[112:113], v[180:181]
    v_pk_mul_f32 v[114:115], v[114:115], v[182:183]
    v_pk_mul_f32 v[116:117], v[116:117], v[184:185]
    v_pk_mul_f32 v[118:119], v[118:119], v[186:187]
    v_pk_mul_f32 v[120:121], v[120:121], v[188:189]
    v_pk_mul_f32 v[122:123], v[122:123], v[190:191]
    v_pk_mul_f32 v[124:125], v[124:125], v[192:193]
    v_pk_mul_f32 v[126:127], v[126:127], v[194:195]
    v_pk_mul_f32 v[128:129], v[128:129], v[196:197]
    v_pk_mul_f32 v[130:131], v[130:131], v[198:199]
    v_pk_mul_f32 v[132:133], v[132:133], v[200:201]
    v_pk_mul_f32 v[134:135], v[134:135], v[202:203]
    v_exp_f32 v108, v108
    v_exp_f32 v109, v109
    v_exp_f32 v110, v110
    v_exp_f32 v111, v111
    v_exp_f32 v112, v112
    v_exp_f32 v113, v113
    v_exp_f32 v114, v114
    v_exp_f32 v115, v115
    v_exp_f32 v116, v116
    v_exp_f32 v117, v117
    v_exp_f32 v118, v118
    v_exp_f32 v119, v119
    v_exp_f32 v120, v120
    v_exp_f32 v121, v121
    v_exp_f32 v122, v122
    v_exp_f32 v123, v123
    v_exp_f32 v124, v124
    v_exp_f32 v125, v125
    v_exp_f32 v126, v126
    v_exp_f32 v127, v127
    v_exp_f32 v128, v128
    v_exp_f32 v129, v129
    v_exp_f32 v130, v130
    v_exp_f32 v131, v131
    v_exp_f32 v132, v132
    v_exp_f32 v133, v133
    v_exp_f32 v134, v134
    v_exp_f32 v135, v135
    v_pk_add_f32 v[108:109], v[108:109], 1.0 op_sel_hi:[1,0]
    v_pk_add_f32 v[110:111], v[110:111], 1.0 op_sel_hi:[1,0]
    v_pk_add_f32 v[112:113], v[112:113], 1.0 op_sel_hi:[1,0]
    v_pk_add_f32 v[114:115], v[114:115], 1.0 op_sel_hi:[1,0]
    v_pk_add_f32 v[116:117], v[116:117], 1.0 op_sel_hi:[1,0]
    v_pk_add_f32 v[118:119], v[118:119], 1.0 op_sel_hi:[1,0]
    v_pk_add_f32 v[120:121], v[120:121], 1.0 op_sel_hi:[1,0]
    v_pk_add_f32 v[122:123], v[122:123], 1.0 op_sel_hi:[1,0]
    v_pk_add_f32 v[124:125], v[124:125], 1.0 op_sel_hi:[1,0]
    v_pk_add_f32 v[126:127], v[126:127], 1.0 op_sel_hi:[1,0]
    v_pk_add_f32 v[128:129], v[128:129], 1.0 op_sel_hi:[1,0]
    v_pk_add_f32 v[130:131], v[130:131], 1.0 op_sel_hi:[1,0]
    v_pk_add_f32 v[132:133], v[132:133], 1.0 op_sel_hi:[1,0]
    v_pk_add_f32 v[134:135], v[134:135], 1.0 op_sel_hi:[1,0]
    v_rcp_f32 v108, v108
    v_rcp_f32 v109, v109
    v_rcp_f32 v110, v110
    v_rcp_f32 v111, v111
    v_rcp_f32 v112, v112
    v_rcp_f32 v113, v113
    v_rcp_f32 v114, v114
    v_rcp_f32 v115, v115
    v_rcp_f32 v116, v116
    v_rcp_f32 v117, v117
    v_rcp_f32 v118, v118
    v_rcp_f32 v119, v119
    v_rcp_f32 v120, v120
    v_rcp_f32 v121, v121
    v_rcp_f32 v122, v122
    v_rcp_f32 v123, v123
    v_rcp_f32 v124, v124
    v_rcp_f32 v125, v125
    v_rcp_f32 v126, v126
    v_rcp_f32 v127, v127
    v_rcp_f32 v128, v128
    v_rcp_f32 v129, v129
    v_rcp_f32 v130, v130
    v_rcp_f32 v131, v131
    v_rcp_f32 v132, v132
    v_rcp_f32 v133, v133
    v_rcp_f32 v134, v134
    v_rcp_f32 v135, v135
    v_pk_mul_f32 v[176:177], v[176:177], v[108:109]
    v_pk_mul_f32 v[178:179], v[178:179], v[110:111]
    v_pk_mul_f32 v[180:181], v[180:181], v[112:113]
    v_pk_mul_f32 v[182:183], v[182:183], v[114:115]
    v_pk_mul_f32 v[184:185], v[184:185], v[116:117]
    v_pk_mul_f32 v[186:187], v[186:187], v[118:119]
    v_pk_mul_f32 v[188:189], v[188:189], v[120:121]
    v_pk_mul_f32 v[190:191], v[190:191], v[122:123]
    v_pk_mul_f32 v[192:193], v[192:193], v[124:125]
    v_pk_mul_f32 v[194:195], v[194:195], v[126:127]
    v_pk_mul_f32 v[196:197], v[196:197], v[128:129]
    v_pk_mul_f32 v[198:199], v[198:199], v[130:131]
    v_pk_mul_f32 v[200:201], v[200:201], v[132:133]
    v_pk_mul_f32 v[202:203], v[202:203], v[134:135]
    v_pk_mul_f32 v[108:109], v[204:205], v[204:205]
    v_pk_mul_f32 v[110:111], v[206:207], v[206:207]
    v_pk_mul_f32 v[112:113], v[208:209], v[208:209]
    v_pk_mul_f32 v[114:115], v[210:211], v[210:211]
    v_pk_mul_f32 v[116:117], v[212:213], v[212:213]
    v_pk_mul_f32 v[118:119], v[214:215], v[214:215]
    v_pk_mul_f32 v[120:121], v[216:217], v[216:217]
    v_pk_mul_f32 v[122:123], v[218:219], v[218:219]
    v_pk_mul_f32 v[124:125], v[220:221], v[220:221]
    v_pk_mul_f32 v[126:127], v[222:223], v[222:223]
    v_pk_mul_f32 v[128:129], v[224:225], v[224:225]
    v_pk_mul_f32 v[130:131], v[226:227], v[226:227]
    v_pk_mul_f32 v[132:133], v[228:229], v[228:229]
    v_pk_mul_f32 v[134:135], v[230:231], v[230:231]
    v_pk_fma_f32 v[108:109], v[108:109], v[232:233], v[234:235]
    v_pk_fma_f32 v[110:111], v[110:111], v[232:233], v[234:235]
    v_pk_fma_f32 v[112:113], v[112:113], v[232:233], v[234:235]
    v_pk_fma_f32 v[114:115], v[114:115], v[232:233], v[234:235]
    v_pk_fma_f32 v[116:117], v[116:117], v[232:233], v[234:235]
    v_pk_fma_f32 v[118:119], v[118:119], v[232:233], v[234:235]
    v_pk_fma_f32 v[120:121], v[120:121], v[232:233], v[234:235]
    v_pk_fma_f32 v[122:123], v[122:123], v[232:233], v[234:235]
    v_pk_fma_f32 v[124:125], v[124:125], v[232:233], v[234:235]
    v_pk_fma_f32 v[126:127], v[126:127], v[232:233], v[234:235]
    v_pk_fma_f32 v[128:129], v[128:129], v[232:233], v[234:235]
    v_pk_fma_f32 v[130:131], v[130:131], v[232:233], v[234:235]
    v_pk_fma_f32 v[132:133], v[132:133], v[232:233], v[234:235]
    v_pk_fma_f32 v[134:135], v[134:135], v[232:233], v[234:235]
    v_pk_mul_f32 v[108:109], v[108:109], v[204:205]
    v_pk_mul_f32 v[110:111], v[110:111], v[206:207]
    v_pk_mul_f32 v[112:113], v[112:113], v[208:209]
    v_pk_mul_f32 v[114:115], v[114:115], v[210:211]
    v_pk_mul_f32 v[116:117], v[116:117], v[212:213]
    v_pk_mul_f32 v[118:119], v[118:119], v[214:215]
    v_pk_mul_f32 v[120:121], v[120:121], v[216:217]
    v_pk_mul_f32 v[122:123], v[122:123], v[218:219]
    v_pk_mul_f32 v[124:125], v[124:125], v[220:221]
    v_pk_mul_f32 v[126:127], v[126:127], v[222:223]
    v_pk_mul_f32 v[128:129], v[128:129], v[224:225]
    v_pk_mul_f32 v[130:131], v[130:131], v[226:227]
    v_pk_mul_f32 v[132:133], v[132:133], v[228:229]
    v_pk_mul_f32 v[134:135], v[134:135], v[230:231]
    v_exp_f32 v108, v108
    v_exp_f32 v109, v109
    v_exp_f32 v110, v110
    v_exp_f32 v111, v111
    v_exp_f32 v112, v112
    v_exp_f32 v113, v113
    v_exp_f32 v114, v114
    v_exp_f32 v115, v115
    v_exp_f32 v116, v116
    v_exp_f32 v117, v117
    v_exp_f32 v118, v118
    v_exp_f32 v119, v119
    v_exp_f32 v120, v120
    v_exp_f32 v121, v121
    v_exp_f32 v122, v122
    v_exp_f32 v123, v123
    v_exp_f32 v124, v124
    v_exp_f32 v125, v125
    v_exp_f32 v126, v126
    v_exp_f32 v127, v127
    v_exp_f32 v128, v128
    v_exp_f32 v129, v129
    v_exp_f32 v130, v130
    v_exp_f32 v131, v131
    v_exp_f32 v132, v132
    v_exp_f32 v133, v133
    v_exp_f32 v134, v134
    v_exp_f32 v135, v135
    v_pk_add_f32 v[108:109], v[108:109], 1.0 op_sel_hi:[1,0]
    v_pk_add_f32 v[110:111], v[110:111], 1.0 op_sel_hi:[1,0]
    v_pk_add_f32 v[112:113], v[112:113], 1.0 op_sel_hi:[1,0]
    v_pk_add_f32 v[114:115], v[114:115], 1.0 op_sel_hi:[1,0]
    v_pk_add_f32 v[116:117], v[116:117], 1.0 op_sel_hi:[1,0]
    v_pk_add_f32 v[118:119], v[118:119], 1.0 op_sel_hi:[1,0]
    v_pk_add_f32 v[120:121], v[120:121], 1.0 op_sel_hi:[1,0]
    v_pk_add_f32 v[122:123], v[122:123], 1.0 op_sel_hi:[1,0]
    v_pk_add_f32 v[124:125], v[124:125], 1.0 op_sel_hi:[1,0]
    v_pk_add_f32 v[126:127], v[126:127], 1.0 op_sel_hi:[1,0]
    v_pk_add_f32 v[128:129], v[128:129], 1.0 op_sel_hi:[1,0]
    v_pk_add_f32 v[130:131], v[130:131], 1.0 op_sel_hi:[1,0]
    v_pk_add_f32 v[132:133], v[132:133], 1.0 op_sel_hi:[1,0]
    v_pk_add_f32 v[134:135], v[134:135], 1.0 op_sel_hi:[1,0]
    v_rcp_f32 v108, v108
    v_rcp_f32 v109, v109
    v_rcp_f32 v110, v110
    v_rcp_f32 v111, v111
    v_rcp_f32 v112, v112
    v_rcp_f32 v113, v113
    v_rcp_f32 v114, v114
    v_rcp_f32 v115, v115
    v_rcp_f32 v116, v116
    v_rcp_f32 v117, v117
    v_rcp_f32 v118, v118
    v_rcp_f32 v119, v119
    v_rcp_f32 v120, v120
    v_rcp_f32 v121, v121
    v_rcp_f32 v122, v122
    v_rcp_f32 v123, v123
    v_rcp_f32 v124, v124
    v_rcp_f32 v125, v125
    v_rcp_f32 v126, v126
    v_rcp_f32 v127, v127
    v_rcp_f32 v128, v128
    v_rcp_f32 v129, v129
    v_rcp_f32 v130, v130
    v_rcp_f32 v131, v131
    v_rcp_f32 v132, v132
    v_rcp_f32 v133, v133
    v_rcp_f32 v134, v134
    v_rcp_f32 v135, v135
    v_pk_mul_f32 v[204:205], v[204:205], v[108:109]
    v_pk_mul_f32 v[206:207], v[206:207], v[110:111]
    v_pk_mul_f32 v[208:209], v[208:209], v[112:113]
    v_pk_mul_f32 v[210:211], v[210:211], v[114:115]
    v_pk_mul_f32 v[212:213], v[212:213], v[116:117]
    v_pk_mul_f32 v[214:215], v[214:215], v[118:119]
    v_pk_mul_f32 v[216:217], v[216:217], v[120:121]
    v_pk_mul_f32 v[218:219], v[218:219], v[122:123]
    v_pk_mul_f32 v[220:221], v[220:221], v[124:125]
    v_pk_mul_f32 v[222:223], v[222:223], v[126:127]
    v_pk_mul_f32 v[224:225], v[224:225], v[128:129]
    v_pk_mul_f32 v[226:227], v[226:227], v[130:131]
    v_pk_mul_f32 v[228:229], v[228:229], v[132:133]
    v_pk_mul_f32 v[230:231], v[230:231], v[134:135]
    v_pk_add_f32 v[108:109], v[176:177], v[184:185]
    v_pk_mul_f32 v[110:111], v[176:177], v[176:177]
    v_pk_add_f32 v[112:113], v[178:179], v[186:187]
    v_pk_mul_f32 v[114:115], v[178:179], v[178:179]
    v_pk_add_f32 v[116:117], v[180:181], v[188:189]
    v_pk_mul_f32 v[118:119], v[180:181], v[180:181]
    v_pk_add_f32 v[120:121], v[182:183], v[190:191]
    v_pk_mul_f32 v[122:123], v[182:183], v[182:183]
    v_pk_fma_f32 v[110:111], v[184:185], v[184:185], v[110:111]
    v_pk_fma_f32 v[114:115], v[186:187], v[186:187], v[114:115]
    v_pk_fma_f32 v[118:119], v[188:189], v[188:189], v[118:119]
    v_pk_fma_f32 v[122:123], v[190:191], v[190:191], v[122:123]
    v_pk_add_f32 v[108:109], v[108:109], v[192:193]
    v_pk_fma_f32 v[110:111], v[192:193], v[192:193], v[110:111]
    v_pk_add_f32 v[112:113], v[112:113], v[194:195]
    v_pk_fma_f32 v[114:115], v[194:195], v[194:195], v[114:115]
    v_pk_add_f32 v[116:117], v[116:117], v[196:197]
    v_pk_fma_f32 v[118:119], v[196:197], v[196:197], v[118:119]
    v_pk_add_f32 v[120:121], v[120:121], v[198:199]
    v_pk_fma_f32 v[122:123], v[198:199], v[198:199], v[122:123]
    v_pk_add_f32 v[108:109], v[108:109], v[200:201]
    v_pk_fma_f32 v[110:111], v[200:201], v[200:201], v[110:111]
    v_pk_add_f32 v[112:113], v[112:113], v[202:203]
    v_pk_fma_f32 v[114:115], v[202:203], v[202:203], v[114:115]
    v_pk_add_f32 v[116:117], v[116:117], v[204:205]
    v_pk_fma_f32 v[118:119], v[204:205], v[204:205], v[118:119]
    v_pk_add_f32 v[120:121], v[120:121], v[206:207]
    v_pk_fma_f32 v[122:123], v[206:207], v[206:207], v[122:123]
    v_pk_add_f32 v[108:109], v[108:109], v[208:209]
    v_pk_fma_f32 v[110:111], v[208:209], v[208:209], v[110:111]
    v_pk_add_f32 v[112:113], v[112:113], v[210:211]
    v_pk_fma_f32 v[114:115], v[210:211], v[210:211], v[114:115]
    v_pk_add_f32 v[116:117], v[116:117], v[212:213]
    v_pk_fma_f32 v[118:119], v[212:213], v[212:213], v[118:119]
    v_pk_add_f32 v[120:121], v[120:121], v[214:215]
    v_pk_fma_f32 v[122:123], v[214:215], v[214:215], v[122:123]
    v_pk_add_f32 v[108:109], v[108:109], v[216:217]
    v_pk_fma_f32 v[110:111], v[216:217], v[216:217], v[110:111]
    v_pk_add_f32 v[112:113], v[112:113], v[218:219]
    v_pk_fma_f32 v[114:115], v[218:219], v[218:219], v[114:115]
    v_pk_add_f32 v[116:117], v[116:117], v[220:221]
    v_pk_fma_f32 v[118:119], v[220:221], v[220:221], v[118:119]
    v_pk_add_f32 v[120:121], v[120:121], v[222:223]
    v_pk_fma_f32 v[122:123], v[222:223], v[222:223], v[122:123]
    v_pk_add_f32 v[108:109], v[108:109], v[224:225]
    v_pk_fma_f32 v[110:111], v[224:225], v[224:225], v[110:111]
    v_pk_add_f32 v[112:113], v[112:113], v[226:227]
    v_pk_fma_f32 v[114:115], v[226:227], v[226:227], v[114:115]
    v_pk_add_f32 v[116:117], v[116:117], v[228:229]
    v_pk_fma_f32 v[118:119], v[228:229], v[228:229], v[118:119]
    v_pk_add_f32 v[120:121], v[120:121], v[230:231]
    v_pk_fma_f32 v[122:123], v[230:231], v[230:231], v[122:123]
    v_lshlrev_b32 v4, 2, v2
    s_nop 0
    v_add_f32_dpp v108, v108, v108 row_ror:8 row_mask:0xf bank_mask:0x3
    v_add_f32_dpp v109, v109, v109 row_ror:8 row_mask:0xf bank_mask:0x3
    v_add_f32_dpp v110, v110, v110 row_ror:8 row_mask:0xf bank_mask:0x3
    v_add_f32_dpp v111, v111, v111 row_ror:8 row_mask:0xf bank_mask:0x3
    v_add_f32_dpp v112, v112, v112 row_ror:8 row_mask:0xf bank_mask:0x3
    v_add_f32_dpp v113, v113, v113 row_ror:8 row_mask:0xf bank_mask:0x3
    v_add_f32_dpp v114, v114, v114 row_ror:8 row_mask:0xf bank_mask:0x3
    v_add_f32_dpp v115, v115, v115 row_ror:8 row_mask:0xf bank_mask:0x3
    v_add_f32_dpp v108, v116, v116 row_ror:8 row_mask:0xf bank_mask:0xc
    v_add_f32_dpp v109, v117, v117 row_ror:8 row_mask:0xf bank_mask:0xc
    v_add_f32_dpp v110, v118, v118 row_ror:8 row_mask:0xf bank_mask:0xc
    v_add_f32_dpp v111, v119, v119 row_ror:8 row_mask:0xf bank_mask:0xc
    v_add_f32_dpp v112, v120, v120 row_ror:8 row_mask:0xf bank_mask:0xc
    v_add_f32_dpp v113, v121, v121 row_ror:8 row_mask:0xf bank_mask:0xc
    v_add_f32_dpp v114, v122, v122 row_ror:8 row_mask:0xf bank_mask:0xc
    v_add_f32_dpp v115, v123, v123 row_ror:8 row_mask:0xf bank_mask:0xc
    v_add_f32_dpp v108, v108, v108 row_half_mirror row_mask:0xf bank_mask:0x5
    v_add_f32_dpp v109, v109, v109 row_half_mirror row_mask:0xf bank_mask:0x5
    v_add_f32_dpp v110, v110, v110 row_half_mirror row_mask:0xf bank_mask:0x5
    v_add_f32_dpp v111, v111, v111 row_half_mirror row_mask:0xf bank_mask:0x5
    v_add_f32_dpp v108, v112, v112 row_half_mirror row_mask:0xf bank_mask:0xa
    v_add_f32_dpp v109, v113, v113 row_half_mirror row_mask:0xf bank_mask:0xa
    v_add_f32_dpp v110, v114, v114 row_half_mirror row_mask:0xf bank_mask:0xa
    v_add_f32_dpp v111, v115, v115 row_half_mirror row_mask:0xf bank_mask:0xa
    v_add_f32_dpp v108, v108, v108 quad_perm:[1,0,3,2] row_mask:0xf bank_mask:0xf
    v_add_f32_dpp v109, v109, v109 quad_perm:[1,0,3,2] row_mask:0xf bank_mask:0xf
    v_add_f32_dpp v110, v110, v110 quad_perm:[1,0,3,2] row_mask:0xf bank_mask:0xf
    v_add_f32_dpp v111, v111, v111 quad_perm:[1,0,3,2] row_mask:0xf bank_mask:0xf
    v_add_f32_dpp v108, v108, v108 quad_perm:[2,3,0,1] row_mask:0xf bank_mask:0xf
    v_add_f32_dpp v109, v109, v109 quad_perm:[2,3,0,1] row_mask:0xf bank_mask:0xf
    v_add_f32_dpp v110, v110, v110 quad_perm:[2,3,0,1] row_mask:0xf bank_mask:0xf
    v_add_f32_dpp v111, v111, v111 quad_perm:[2,3,0,1] row_mask:0xf bank_mask:0xf
    v_mov_b32 v144, v108
    v_mov_b32 v145, v109
    v_or_b32 v146, 0x80000000, v110
    v_mov_b32 v147, v111
    s_mov_b32 exec_lo, 0x11111111
    s_mov_b32 exec_hi, 0x11111111
    buffer_store_dwordx4 v[144:147], v4, s[32:35], s76 offen sc0 sc1
    s_mov_b64 exec, -1
    v_and_b32 v3, 7, v2
    v_lshlrev_b32 v3, 8, v3
    v_lshrrev_b32 v4, 3, v2
    v_lshl_add_u32 v1, v4, 5, v3
    v_add_u32 v12, s70, v7
    v_add_u32 v13, s70, v11
    s_add_u32 s70, s70, 30720
    s_cmp_ge_u32 s70, 153600
    s_cselect_b32 s70, 0, s70
    s_waitcnt lgkmcnt(0)
    ds_read_b128 v[108:111], v12
    ds_read_b128 v[112:115], v12 offset:2048
    v_mfma_f32_16x16x32_bf16 v[16:19], v[80:83], v[72:75], v[16:19]
    ds_read_b64_tr_b16 v[116:117], v13 offset:7168
    v_mfma_f32_16x16x32_bf16 v[44:47], v[80:83], v[76:79], v[44:47]
    ds_read_b64_tr_b16 v[118:119], v13 offset:8960
    v_mfma_f32_16x16x32_bf16 v[20:23], v[84:87], v[72:75], v[20:23]
    ds_read_b64_tr_b16 v[120:121], v13 offset:7200
    v_mfma_f32_16x16x32_bf16 v[48:51], v[84:87], v[76:79], v[48:51]
    ds_read_b64_tr_b16 v[122:123], v13 offset:8992
    v_mfma_f32_16x16x32_bf16 v[24:27], v[88:91], v[72:75], v[24:27]
    ds_read_b64_tr_b16 v[124:125], v13 offset:7232
    v_mfma_f32_16x16x32_bf16 v[52:55], v[88:91], v[76:79], v[52:55]
    ds_read_b64_tr_b16 v[126:127], v13 offset:9024
    v_mfma_f32_16x16x32_bf16 v[28:31], v[92:95], v[72:75], v[28:31]
    ds_read_b64_tr_b16 v[128:129], v13 offset:7264
    v_mfma_f32_16x16x32_bf16 v[56:59], v[92:95], v[76:79], v[56:59]
    ds_read_b64_tr_b16 v[130:131], v13 offset:9056
    v_mfma_f32_16x16x32_bf16 v[32:35], v[96:99], v[72:75], v[32:35]
    ds_read_b64_tr_b16 v[132:133], v13 offset:7296
    v_mfma_f32_16x16x32_bf16 v[60:63], v[96:99], v[76:79], v[60:63]
    ds_read_b64_tr_b16 v[134:135], v13 offset:9088
    v_mfma_f32_16x16x32_bf16 v[36:39], v[100:103], v[72:75], v[36:39]
    ds_read_b64_tr_b16 v[136:137], v13 offset:7328
    v_mfma_f32_16x16x32_bf16 v[64:67], v[100:103], v[76:79], v[64:67]
    ds_read_b64_tr_b16 v[138:139], v13 offset:9120
    v_mfma_f32_16x16x32_bf16 v[40:43], v[104:107], v[72:75], v[40:43]
    ds_read_b64_tr_b16 v[140:141], v13 offset:7360
    v_mfma_f32_16x16x32_bf16 v[68:71], v[104:107], v[76:79], v[68:71]
    ds_read_b64_tr_b16 v[142:143], v13 offset:9152
    v_add_u32 v9, s70, v6
    v_add_u32 v10, s70, v11
    s_waitcnt lgkmcnt(0)
    s_barrier
    ds_read_b128 v[72:75], v9
    ds_read_b128 v[76:79], v9 offset:2048
    v_mfma_f32_16x16x32_bf16 v[16:19], v[116:119], v[108:111], v[16:19]
    ds_read_b64_tr_b16 v[80:81], v10 offset:0
    v_mfma_f32_16x16x32_bf16 v[44:47], v[116:119], v[112:115], v[44:47]
    ds_read_b64_tr_b16 v[82:83], v10 offset:1792
    v_mfma_f32_16x16x32_bf16 v[20:23], v[120:123], v[108:111], v[20:23]
    ds_read_b64_tr_b16 v[84:85], v10 offset:32
    v_mfma_f32_16x16x32_bf16 v[48:51], v[120:123], v[112:115], v[48:51]
    ds_read_b64_tr_b16 v[86:87], v10 offset:1824
    v_mfma_f32_16x16x32_bf16 v[24:27], v[124:127], v[108:111], v[24:27]
    ds_read_b64_tr_b16 v[88:89], v10 offset:64
    v_mfma_f32_16x16x32_bf16 v[52:55], v[124:127], v[112:115], v[52:55]
    ds_read_b64_tr_b16 v[90:91], v10 offset:1856
    v_mfma_f32_16x16x32_bf16 v[28:31], v[128:131], v[108:111], v[28:31]
    ds_read_b64_tr_b16 v[92:93], v10 offset:96
    v_mfma_f32_16x16x32_bf16 v[56:59], v[128:131], v[112:115], v[56:59]
    ds_read_b64_tr_b16 v[94:95], v10 offset:1888
    v_mfma_f32_16x16x32_bf16 v[32:35], v[132:135], v[108:111], v[32:35]
    ds_read_b64_tr_b16 v[96:97], v10 offset:128
    v_mfma_f32_16x16x32_bf16 v[60:63], v[132:135], v[112:115], v[60:63]
    ds_read_b64_tr_b16 v[98:99], v10 offset:1920
    v_mfma_f32_16x16x32_bf16 v[36:39], v[136:139], v[108:111], v[36:39]
    ds_read_b64_tr_b16 v[100:101], v10 offset:160
    v_mfma_f32_16x16x32_bf16 v[64:67], v[136:139], v[112:115], v[64:67]
    ds_read_b64_tr_b16 v[102:103], v10 offset:1952
    v_mfma_f32_16x16x32_bf16 v[40:43], v[140:143], v[108:111], v[40:43]
    ds_read_b64_tr_b16 v[104:105], v10 offset:192
    v_mfma_f32_16x16x32_bf16 v[68:71], v[140:143], v[112:115], v[68:71]
    ds_read_b64_tr_b16 v[106:107], v10 offset:1984
    v_add_u32 v12, s70, v7
    v_add_u32 v13, s70, v11
    s_add_u32 s70, s70, 30720
    s_cmp_ge_u32 s70, 153600
    s_cselect_b32 s70, 0, s70
    s_waitcnt lgkmcnt(0)
    ds_read_b128 v[108:111], v12
    ds_read_b128 v[112:115], v12 offset:2048
    v_mfma_f32_16x16x32_bf16 v[16:19], v[80:83], v[72:75], v[16:19]
    ds_read_b64_tr_b16 v[116:117], v13 offset:7168
    v_mfma_f32_16x16x32_bf16 v[44:47], v[80:83], v[76:79], v[44:47]
    ds_read_b64_tr_b16 v[118:119], v13 offset:8960
    v_mfma_f32_16x16x32_bf16 v[20:23], v[84:87], v[72:75], v[20:23]
    ds_read_b64_tr_b16 v[120:121], v13 offset:7200
    v_mfma_f32_16x16x32_bf16 v[48:51], v[84:87], v[76:79], v[48:51]
    ds_read_b64_tr_b16 v[122:123], v13 offset:8992
    v_mfma_f32_16x16x32_bf16 v[24:27], v[88:91], v[72:75], v[24:27]
    ds_read_b64_tr_b16 v[124:125], v13 offset:7232
    v_mfma_f32_16x16x32_bf16 v[52:55], v[88:91], v[76:79], v[52:55]
    ds_read_b64_tr_b16 v[126:127], v13 offset:9024
    v_mfma_f32_16x16x32_bf16 v[28:31], v[92:95], v[72:75], v[28:31]
    ds_read_b64_tr_b16 v[128:129], v13 offset:7264
    v_mfma_f32_16x16x32_bf16 v[56:59], v[92:95], v[76:79], v[56:59]
    ds_read_b64_tr_b16 v[130:131], v13 offset:9056
    v_mfma_f32_16x16x32_bf16 v[32:35], v[96:99], v[72:75], v[32:35]
    ds_read_b64_tr_b16 v[132:133], v13 offset:7296
    v_mfma_f32_16x16x32_bf16 v[60:63], v[96:99], v[76:79], v[60:63]
    ds_read_b64_tr_b16 v[134:135], v13 offset:9088
    v_mfma_f32_16x16x32_bf16 v[36:39], v[100:103], v[72:75], v[36:39]
    ds_read_b64_tr_b16 v[136:137], v13 offset:7328
    v_mfma_f32_16x16x32_bf16 v[64:67], v[100:103], v[76:79], v[64:67]
    ds_read_b64_tr_b16 v[138:139], v13 offset:9120
    v_mfma_f32_16x16x32_bf16 v[40:43], v[104:107], v[72:75], v[40:43]
    ds_read_b64_tr_b16 v[140:141], v13 offset:7360
    v_mfma_f32_16x16x32_bf16 v[68:71], v[104:107], v[76:79], v[68:71]
    ds_read_b64_tr_b16 v[142:143], v13 offset:9152
    v_add_u32 v9, s70, v6
    v_add_u32 v10, s70, v11
    s_waitcnt lgkmcnt(0)
    s_barrier
    buffer_load_dwordx4 v[148:151], v1, s[32:35], s75 offen sc0 sc1
    buffer_load_dwordx4 v[152:155], v1, s[32:35], s75 offen offset:16 sc0 sc1
    ds_read_b128 v[72:75], v9
    ds_read_b128 v[76:79], v9 offset:2048
    v_mfma_f32_16x16x32_bf16 v[16:19], v[116:119], v[108:111], v[16:19]
    ds_read_b64_tr_b16 v[80:81], v10 offset:0
    v_mfma_f32_16x16x32_bf16 v[44:47], v[116:119], v[112:115], v[44:47]
    ds_read_b64_tr_b16 v[82:83], v10 offset:1792
    v_mfma_f32_16x16x32_bf16 v[20:23], v[120:123], v[108:111], v[20:23]
    ds_read_b64_tr_b16 v[84:85], v10 offset:32
    v_mfma_f32_16x16x32_bf16 v[48:51], v[120:123], v[112:115], v[48:51]
    ds_read_b64_tr_b16 v[86:87], v10 offset:1824
    v_mfma_f32_16x16x32_bf16 v[24:27], v[124:127], v[108:111], v[24:27]
    ds_read_b64_tr_b16 v[88:89], v10 offset:64
    v_mfma_f32_16x16x32_bf16 v[52:55], v[124:127], v[112:115], v[52:55]
    ds_read_b64_tr_b16 v[90:91], v10 offset:1856
    v_mfma_f32_16x16x32_bf16 v[28:31], v[128:131], v[108:111], v[28:31]
    ds_read_b64_tr_b16 v[92:93], v10 offset:96
    v_mfma_f32_16x16x32_bf16 v[56:59], v[128:131], v[112:115], v[56:59]
    ds_read_b64_tr_b16 v[94:95], v10 offset:1888
    v_mfma_f32_16x16x32_bf16 v[32:35], v[132:135], v[108:111], v[32:35]
    ds_read_b64_tr_b16 v[96:97], v10 offset:128
    v_mfma_f32_16x16x32_bf16 v[60:63], v[132:135], v[112:115], v[60:63]
    ds_read_b64_tr_b16 v[98:99], v10 offset:1920
    v_mfma_f32_16x16x32_bf16 v[36:39], v[136:139], v[108:111], v[36:39]
    ds_read_b64_tr_b16 v[100:101], v10 offset:160
    v_mfma_f32_16x16x32_bf16 v[64:67], v[136:139], v[112:115], v[64:67]
    ds_read_b64_tr_b16 v[102:103], v10 offset:1952
    v_mfma_f32_16x16x32_bf16 v[40:43], v[140:143], v[108:111], v[40:43]
    ds_read_b64_tr_b16 v[104:105], v10 offset:192
    v_mfma_f32_16x16x32_bf16 v[68:71], v[140:143], v[112:115], v[68:71]
    ds_read_b64_tr_b16 v[106:107], v10 offset:1984
    v_add_u32 v12, s70, v7
    v_add_u32 v13, s70, v11
    s_add_u32 s70, s70, 30720
    s_cmp_ge_u32 s70, 153600
    s_cselect_b32 s70, 0, s70
    s_waitcnt lgkmcnt(0)
    ds_read_b128 v[108:111], v12
    ds_read_b128 v[112:115], v12 offset:2048
    v_mfma_f32_16x16x32_bf16 v[16:19], v[80:83], v[72:75], v[16:19]
    ds_read_b64_tr_b16 v[116:117], v13 offset:7168
    v_mfma_f32_16x16x32_bf16 v[44:47], v[80:83], v[76:79], v[44:47]
    ds_read_b64_tr_b16 v[118:119], v13 offset:8960
    v_mfma_f32_16x16x32_bf16 v[20:23], v[84:87], v[72:75], v[20:23]
    ds_read_b64_tr_b16 v[120:121], v13 offset:7200
    v_mfma_f32_16x16x32_bf16 v[48:51], v[84:87], v[76:79], v[48:51]
    ds_read_b64_tr_b16 v[122:123], v13 offset:8992
    v_mfma_f32_16x16x32_bf16 v[24:27], v[88:91], v[72:75], v[24:27]
    ds_read_b64_tr_b16 v[124:125], v13 offset:7232
    v_mfma_f32_16x16x32_bf16 v[52:55], v[88:91], v[76:79], v[52:55]
    ds_read_b64_tr_b16 v[126:127], v13 offset:9024
    v_mfma_f32_16x16x32_bf16 v[28:31], v[92:95], v[72:75], v[28:31]
    ds_read_b64_tr_b16 v[128:129], v13 offset:7264
    v_mfma_f32_16x16x32_bf16 v[56:59], v[92:95], v[76:79], v[56:59]
    ds_read_b64_tr_b16 v[130:131], v13 offset:9056
    v_mfma_f32_16x16x32_bf16 v[32:35], v[96:99], v[72:75], v[32:35]
    ds_read_b64_tr_b16 v[132:133], v13 offset:7296
    v_mfma_f32_16x16x32_bf16 v[60:63], v[96:99], v[76:79], v[60:63]
    ds_read_b64_tr_b16 v[134:135], v13 offset:9088
    v_mfma_f32_16x16x32_bf16 v[36:39], v[100:103], v[72:75], v[36:39]
    ds_read_b64_tr_b16 v[136:137], v13 offset:7328
    v_mfma_f32_16x16x32_bf16 v[64:67], v[100:103], v[76:79], v[64:67]
    ds_read_b64_tr_b16 v[138:139], v13 offset:9120
    v_mfma_f32_16x16x32_bf16 v[40:43], v[104:107], v[72:75], v[40:43]
    ds_read_b64_tr_b16 v[140:141], v13 offset:7360
    v_mfma_f32_16x16x32_bf16 v[68:71], v[104:107], v[76:79], v[68:71]
    ds_read_b64_tr_b16 v[142:143], v13 offset:9152
    v_add_u32 v9, s70, v6
    v_add_u32 v10, s70, v11
    s_waitcnt lgkmcnt(0)
    s_barrier
    s_mov_b32 s78, 0
C_LN_CHK:
    s_waitcnt vmcnt(0)
    v_and_b32 v3, v150, v154
    v_cmp_gt_i32 vcc, 0, v3
    s_cmp_eq_u64 vcc, -1
    s_cbranch_scc1 C_LN_OK
    s_add_u32 s78, s78, 1
    s_cmp_ge_u32 s78, 0x40000
    s_cbranch_scc1 C_LN_OK
    buffer_load_dwordx4 v[148:151], v1, s[32:35], s75 offen sc0 sc1
    buffer_load_dwordx4 v[152:155], v1, s[32:35], s75 offen offset:16 sc0 sc1
    s_branch C_LN_CHK
C_LN_OK:
    v_and_b32 v150, 0x7fffffff, v150
    v_and_b32 v154, 0x7fffffff, v154
    s_nop 0
    v_add_f32_dpp v148, v148, v148 row_half_mirror row_mask:0xf bank_mask:0xf
    v_add_f32_dpp v149, v149, v149 row_half_mirror row_mask:0xf bank_mask:0xf
    v_add_f32_dpp v151, v151, v151 row_half_mirror row_mask:0xf bank_mask:0xf
    v_add_f32_dpp v152, v152, v152 row_half_mirror row_mask:0xf bank_mask:0xf
    v_add_f32_dpp v153, v153, v153 row_half_mirror row_mask:0xf bank_mask:0xf
    v_add_f32_dpp v155, v155, v155 row_half_mirror row_mask:0xf bank_mask:0xf
    v_add_f32_dpp v150, v150, v150 row_half_mirror row_mask:0xf bank_mask:0xf
    v_add_f32_dpp v154, v154, v154 row_half_mirror row_mask:0xf bank_mask:0xf
    v_add_f32_dpp v148, v148, v148 quad_perm:[1,0,3,2] row_mask:0xf bank_mask:0xf
    v_add_f32_dpp v149, v149, v149 quad_perm:[1,0,3,2] row_mask:0xf bank_mask:0xf
    v_add_f32_dpp v151, v151, v151 quad_perm:[1,0,3,2] row_mask:0xf bank_mask:0xf
    v_add_f32_dpp v152, v152, v152 quad_perm:[1,0,3,2] row_mask:0xf bank_mask:0xf
    v_add_f32_dpp v153, v153, v153 quad_perm:[1,0,3,2] row_mask:0xf bank_mask:0xf
    v_add_f32_dpp v155, v155, v155 quad_perm:[1,0,3,2] row_mask:0xf bank_mask:0xf
    v_add_f32_dpp v150, v150, v150 quad_perm:[1,0,3,2] row_mask:0xf bank_mask:0xf
    v_add_f32_dpp v154, v154, v154 quad_perm:[1,0,3,2] row_mask:0xf bank_mask:0xf
    v_add_f32_dpp v148, v148, v148 quad_perm:[2,3,0,1] row_mask:0xf bank_mask:0xf
    v_add_f32_dpp v149, v149, v149 quad_perm:[2,3,0,1] row_mask:0xf bank_mask:0xf
    v_add_f32_dpp v151, v151, v151 quad_perm:[2,3,0,1] row_mask:0xf bank_mask:0xf
    v_add_f32_dpp v152, v152, v152 quad_perm:[2,3,0,1] row_mask:0xf bank_mask:0xf
    v_add_f32_dpp v153, v153, v153 quad_perm:[2,3,0,1] row_mask:0xf bank_mask:0xf
    v_add_f32_dpp v155, v155, v155 quad_perm:[2,3,0,1] row_mask:0xf bank_mask:0xf
    v_add_f32_dpp v150, v150, v150 quad_perm:[2,3,0,1] row_mask:0xf bank_mask:0xf
    v_add_f32_dpp v154, v154, v154 quad_perm:[2,3,0,1] row_mask:0xf bank_mask:0xf
    v_mul_f32 v148, 0x3a924925, v148
    v_mul_f32 v149, 0x3a924925, v149
    v_mul_f32 v151, 0x3a924925, v151
    v_mul_f32 v152, 0x3a924925, v152
    v_mul_f32 v153, 0x3a924925, v153
    v_mul_f32 v155, 0x3a924925, v155
    v_mul_f32 v150, 0x3a924925, v150
    v_mul_f32 v154, 0x3a924925, v154
    v_fma_f32 v150, -v148, v148, v150
    v_fma_f32 v151, -v149, v149, v151
    v_fma_f32 v154, -v152, v152, v154
    v_fma_f32 v155, -v153, v153, v155
    v_max_f32 v150, 0, v150
    v_max_f32 v151, 0, v151
    v_max_f32 v154, 0, v154
    v_max_f32 v155, 0, v155
    v_add_f32 v150, 0x3727c5ac, v150
    v_add_f32 v151, 0x3727c5ac, v151
    v_add_f32 v154, 0x3727c5ac, v154
    v_add_f32 v155, 0x3727c5ac, v155
    v_rsq_f32 v150, v150
    v_rsq_f32 v151, v151
    v_rsq_f32 v154, v154
    v_rsq_f32 v155, v155
    s_nop 0
    v_mul_f32 v148, -v148, v150
    v_mul_f32 v149, -v149, v151
    v_mul_f32 v152, -v152, v154
    v_mul_f32 v153, -v153, v155
    v_mov_b32_dpp v156, v150 row_newbcast:0 row_mask:0xf bank_mask:0xf
    v_mov_b32_dpp v157, v151 row_newbcast:0 row_mask:0xf bank_mask:0xf
    v_mov_b32_dpp v158, v154 row_newbcast:0 row_mask:0xf bank_mask:0xf
    v_mov_b32_dpp v159, v155 row_newbcast:0 row_mask:0xf bank_mask:0xf
    v_mov_b32_dpp v160, v150 row_newbcast:8 row_mask:0xf bank_mask:0xf
    v_mov_b32_dpp v161, v151 row_newbcast:8 row_mask:0xf bank_mask:0xf
    v_mov_b32_dpp v162, v154 row_newbcast:8 row_mask:0xf bank_mask:0xf
    v_mov_b32_dpp v163, v155 row_newbcast:8 row_mask:0xf bank_mask:0xf
    v_mov_b32_dpp v164, v148 row_newbcast:0 row_mask:0xf bank_mask:0xf
    v_mov_b32_dpp v165, v149 row_newbcast:0 row_mask:0xf bank_mask:0xf
    v_mov_b32_dpp v166, v152 row_newbcast:0 row_mask:0xf bank_mask:0xf
    v_mov_b32_dpp v167, v153 row_newbcast:0 row_mask:0xf bank_mask:0xf
    v_mov_b32_dpp v168, v148 row_newbcast:8 row_mask:0xf bank_mask:0xf
    v_mov_b32_dpp v169, v149 row_newbcast:8 row_mask:0xf bank_mask:0xf
    v_mov_b32_dpp v170, v152 row_newbcast:8 row_mask:0xf bank_mask:0xf
    v_mov_b32_dpp v171, v153 row_newbcast:8 row_mask:0xf bank_mask:0xf
    v_pk_fma_f32 v[176:177], v[176:177], v[156:157], v[164:165]
    v_pk_fma_f32 v[178:179], v[178:179], v[158:159], v[166:167]
    v_pk_fma_f32 v[180:181], v[180:181], v[160:161], v[168:169]
    v_pk_fma_f32 v[182:183], v[182:183], v[162:163], v[170:171]
    v_pk_fma_f32 v[184:185], v[184:185], v[156:157], v[164:165]
    v_pk_fma_f32 v[186:187], v[186:187], v[158:159], v[166:167]
    v_pk_fma_f32 v[188:189], v[188:189], v[160:161], v[168:169]
    v_pk_fma_f32 v[190:191], v[190:191], v[162:163], v[170:171]
    v_pk_fma_f32 v[192:193], v[192:193], v[156:157], v[164:165]
    v_pk_fma_f32 v[194:195], v[194:195], v[158:159], v[166:167]
    v_pk_fma_f32 v[196:197], v[196:197], v[160:161], v[168:169]
    v_pk_fma_f32 v[198:199], v[198:199], v[162:163], v[170:171]
    v_pk_fma_f32 v[200:201], v[200:201], v[156:157], v[164:165]
    v_pk_fma_f32 v[202:203], v[202:203], v[158:159], v[166:167]
    v_pk_fma_f32 v[204:205], v[204:205], v[160:161], v[168:169]
    v_pk_fma_f32 v[206:207], v[206:207], v[162:163], v[170:171]
    v_pk_fma_f32 v[208:209], v[208:209], v[156:157], v[164:165]
    v_pk_fma_f32 v[210:211], v[210:211], v[158:159], v[166:167]
    v_pk_fma_f32 v[212:213], v[212:213], v[160:161], v[168:169]
    v_pk_fma_f32 v[214:215], v[214:215], v[162:163], v[170:171]
    v_pk_fma_f32 v[216:217], v[216:217], v[156:157], v[164:165]
    v_pk_fma_f32 v[218:219], v[218:219], v[158:159], v[166:167]
    v_pk_fma_f32 v[220:221], v[220:221], v[160:161], v[168:169]
    v_pk_fma_f32 v[222:223], v[222:223], v[162:163], v[170:171]
    v_pk_fma_f32 v[224:225], v[224:225], v[156:157], v[164:165]
    v_pk_fma_f32 v[226:227], v[226:227], v[158:159], v[166:167]
    v_pk_fma_f32 v[228:229], v[228:229], v[160:161], v[168:169]
    v_pk_fma_f32 v[230:231], v[230:231], v[162:163], v[170:171]
    v_cvt_pk_bf16_f32 v176, v176, v177
    v_cvt_pk_bf16_f32 v177, v178, v179
    v_cvt_pk_bf16_f32 v178, v180, v181
    v_cvt_pk_bf16_f32 v179, v182, v183
    v_cvt_pk_bf16_f32 v180, v184, v185
    v_cvt_pk_bf16_f32 v181, v186, v187
    v_cvt_pk_bf16_f32 v182, v188, v189
    v_cvt_pk_bf16_f32 v183, v190, v191
    v_cvt_pk_bf16_f32 v184, v192, v193
    v_cvt_pk_bf16_f32 v185, v194, v195
    v_cvt_pk_bf16_f32 v186, v196, v197
    v_cvt_pk_bf16_f32 v187, v198, v199
    v_cvt_pk_bf16_f32 v188, v200, v201
    v_cvt_pk_bf16_f32 v189, v202, v203
    v_cvt_pk_bf16_f32 v190, v204, v205
    v_cvt_pk_bf16_f32 v191, v206, v207
    v_cvt_pk_bf16_f32 v192, v208, v209
    v_cvt_pk_bf16_f32 v193, v210, v211
    v_cvt_pk_bf16_f32 v194, v212, v213
    v_cvt_pk_bf16_f32 v195, v214, v215
    v_cvt_pk_bf16_f32 v196, v216, v217
    v_cvt_pk_bf16_f32 v197, v218, v219
    v_cvt_pk_bf16_f32 v198, v220, v221
    v_cvt_pk_bf16_f32 v199, v222, v223
    v_cvt_pk_bf16_f32 v200, v224, v225
    v_cvt_pk_bf16_f32 v201, v226, v227
    v_cvt_pk_bf16_f32 v202, v228, v229
    v_cvt_pk_bf16_f32 v203, v230, v231
    buffer_store_dwordx4 v[176:179], v14, s[32:35], s73 offen offset:0 sc0 sc1
    buffer_store_dwordx4 v[180:183], v14, s[32:35], s73 offen offset:1024 sc0 sc1
    buffer_store_dwordx4 v[184:187], v14, s[32:35], s73 offen offset:2048 sc0 sc1
    buffer_store_dwordx4 v[188:191], v14, s[32:35], s73 offen offset:3072 sc0 sc1
    buffer_store_dwordx4 v[192:195], v14, s[32:35], s77 offen offset:0 sc0 sc1
    buffer_store_dwordx4 v[196:199], v14, s[32:35], s77 offen offset:1024 sc0 sc1
    buffer_store_dwordx4 v[200:203], v14, s[32:35], s77 offen offset:2048 sc0 sc1
    ds_read_b128 v[72:75], v9
    ds_read_b128 v[76:79], v9 offset:2048
    v_mfma_f32_16x16x32_bf16 v[16:19], v[116:119], v[108:111], v[16:19]
    ds_read_b64_tr_b16 v[80:81], v10 offset:0
    v_mfma_f32_16x16x32_bf16 v[44:47], v[116:119], v[112:115], v[44:47]
    ds_read_b64_tr_b16 v[82:83], v10 offset:1792
    v_mfma_f32_16x16x32_bf16 v[20:23], v[120:123], v[108:111], v[20:23]
    ds_read_b64_tr_b16 v[84:85], v10 offset:32
    v_mfma_f32_16x16x32_bf16 v[48:51], v[120:123], v[112:115], v[48:51]
    ds_read_b64_tr_b16 v[86:87], v10 offset:1824
    v_mfma_f32_16x16x32_bf16 v[24:27], v[124:127], v[108:111], v[24:27]
    ds_read_b64_tr_b16 v[88:89], v10 offset:64
    v_mfma_f32_16x16x32_bf16 v[52:55], v[124:127], v[112:115], v[52:55]
    ds_read_b64_tr_b16 v[90:91], v10 offset:1856
    v_mfma_f32_16x16x32_bf16 v[28:31], v[128:131], v[108:111], v[28:31]
    ds_read_b64_tr_b16 v[92:93], v10 offset:96
    v_mfma_f32_16x16x32_bf16 v[56:59], v[128:131], v[112:115], v[56:59]
    ds_read_b64_tr_b16 v[94:95], v10 offset:1888
    v_mfma_f32_16x16x32_bf16 v[32:35], v[132:135], v[108:111], v[32:35]
    ds_read_b64_tr_b16 v[96:97], v10 offset:128
    v_mfma_f32_16x16x32_bf16 v[60:63], v[132:135], v[112:115], v[60:63]
    ds_read_b64_tr_b16 v[98:99], v10 offset:1920
    v_mfma_f32_16x16x32_bf16 v[36:39], v[136:139], v[108:111], v[36:39]
    ds_read_b64_tr_b16 v[100:101], v10 offset:160
    v_mfma_f32_16x16x32_bf16 v[64:67], v[136:139], v[112:115], v[64:67]
    ds_read_b64_tr_b16 v[102:103], v10 offset:1952
    v_mfma_f32_16x16x32_bf16 v[40:43], v[140:143], v[108:111], v[40:43]
    ds_read_b64_tr_b16 v[104:105], v10 offset:192
    v_mfma_f32_16x16x32_bf16 v[68:71], v[140:143], v[112:115], v[68:71]
    ds_read_b64_tr_b16 v[106:107], v10 offset:1984
    v_add_u32 v12, s70, v7
    v_add_u32 v13, s70, v11
    s_add_u32 s70, s70, 30720
    s_cmp_ge_u32 s70, 153600
    s_cselect_b32 s70, 0, s70
    s_waitcnt lgkmcnt(0)
    ds_read_b128 v[108:111], v12
    ds_read_b128 v[112:115], v12 offset:2048
    v_mfma_f32_16x16x32_bf16 v[16:19], v[80:83], v[72:75], v[16:19]
    ds_read_b64_tr_b16 v[116:117], v13 offset:7168
    v_mfma_f32_16x16x32_bf16 v[44:47], v[80:83], v[76:79], v[44:47]
    ds_read_b64_tr_b16 v[118:119], v13 offset:8960
    v_mfma_f32_16x16x32_bf16 v[20:23], v[84:87], v[72:75], v[20:23]
    ds_read_b64_tr_b16 v[120:121], v13 offset:7200
    v_mfma_f32_16x16x32_bf16 v[48:51], v[84:87], v[76:79], v[48:51]
    ds_read_b64_tr_b16 v[122:123], v13 offset:8992
    v_mfma_f32_16x16x32_bf16 v[24:27], v[88:91], v[72:75], v[24:27]
    ds_read_b64_tr_b16 v[124:125], v13 offset:7232
    v_mfma_f32_16x16x32_bf16 v[52:55], v[88:91], v[76:79], v[52:55]
    ds_read_b64_tr_b16 v[126:127], v13 offset:9024
    v_mfma_f32_16x16x32_bf16 v[28:31], v[92:95], v[72:75], v[28:31]
    ds_read_b64_tr_b16 v[128:129], v13 offset:7264
    v_mfma_f32_16x16x32_bf16 v[56:59], v[92:95], v[76:79], v[56:59]
    ds_read_b64_tr_b16 v[130:131], v13 offset:9056
    v_mfma_f32_16x16x32_bf16 v[32:35], v[96:99], v[72:75], v[32:35]
    ds_read_b64_tr_b16 v[132:133], v13 offset:7296
    v_mfma_f32_16x16x32_bf16 v[60:63], v[96:99], v[76:79], v[60:63]
    ds_read_b64_tr_b16 v[134:135], v13 offset:9088
    v_mfma_f32_16x16x32_bf16 v[36:39], v[100:103], v[72:75], v[36:39]
    ds_read_b64_tr_b16 v[136:137], v13 offset:7328
    v_mfma_f32_16x16x32_bf16 v[64:67], v[100:103], v[76:79], v[64:67]
    ds_read_b64_tr_b16 v[138:139], v13 offset:9120
    v_mfma_f32_16x16x32_bf16 v[40:43], v[104:107], v[72:75], v[40:43]
    ds_read_b64_tr_b16 v[140:141], v13 offset:7360
    v_mfma_f32_16x16x32_bf16 v[68:71], v[104:107], v[76:79], v[68:71]
    ds_read_b64_tr_b16 v[142:143], v13 offset:9152
    v_add_u32 v9, s70, v6
    v_add_u32 v10, s70, v11
    s_waitcnt lgkmcnt(0)
    s_barrier
    ds_read_b128 v[72:75], v9
    ds_read_b128 v[76:79], v9 offset:2048
    v_mfma_f32_16x16x32_bf16 v[16:19], v[116:119], v[108:111], v[16:19]
    ds_read_b64_tr_b16 v[80:81], v10 offset:0
    v_mfma_f32_16x16x32_bf16 v[44:47], v[116:119], v[112:115], v[44:47]
    ds_read_b64_tr_b16 v[82:83], v10 offset:1792
    v_mfma_f32_16x16x32_bf16 v[20:23], v[120:123], v[108:111], v[20:23]
    ds_read_b64_tr_b16 v[84:85], v10 offset:32
    v_mfma_f32_16x16x32_bf16 v[48:51], v[120:123], v[112:115], v[48:51]
    ds_read_b64_tr_b16 v[86:87], v10 offset:1824
    v_mfma_f32_16x16x32_bf16 v[24:27], v[124:127], v[108:111], v[24:27]
    ds_read_b64_tr_b16 v[88:89], v10 offset:64
    v_mfma_f32_16x16x32_bf16 v[52:55], v[124:127], v[112:115], v[52:55]
    ds_read_b64_tr_b16 v[90:91], v10 offset:1856
    v_mfma_f32_16x16x32_bf16 v[28:31], v[128:131], v[108:111], v[28:31]
    ds_read_b64_tr_b16 v[92:93], v10 offset:96
    v_mfma_f32_16x16x32_bf16 v[56:59], v[128:131], v[112:115], v[56:59]
    ds_read_b64_tr_b16 v[94:95], v10 offset:1888
    v_mfma_f32_16x16x32_bf16 v[32:35], v[132:135], v[108:111], v[32:35]
    ds_read_b64_tr_b16 v[96:97], v10 offset:128
    v_mfma_f32_16x16x32_bf16 v[60:63], v[132:135], v[112:115], v[60:63]
    ds_read_b64_tr_b16 v[98:99], v10 offset:1920
    v_mfma_f32_16x16x32_bf16 v[36:39], v[136:139], v[108:111], v[36:39]
    ds_read_b64_tr_b16 v[100:101], v10 offset:160
    v_mfma_f32_16x16x32_bf16 v[64:67], v[136:139], v[112:115], v[64:67]
    ds_read_b64_tr_b16 v[102:103], v10 offset:1952
    v_mfma_f32_16x16x32_bf16 v[40:43], v[140:143], v[108:111], v[40:43]
    ds_read_b64_tr_b16 v[104:105], v10 offset:192
    v_mfma_f32_16x16x32_bf16 v[68:71], v[140:143], v[112:115], v[68:71]
    ds_read_b64_tr_b16 v[106:107], v10 offset:1984
    v_add_u32 v12, s70, v7
    v_add_u32 v13, s70, v11
    s_add_u32 s70, s70, 30720
    s_cmp_ge_u32 s70, 153600
    s_cselect_b32 s70, 0, s70
    s_waitcnt lgkmcnt(0)
    ds_read_b128 v[108:111], v12
    ds_read_b128 v[112:115], v12 offset:2048
    v_mfma_f32_16x16x32_bf16 v[16:19], v[80:83], v[72:75], v[16:19]
    ds_read_b64_tr_b16 v[116:117], v13 offset:7168
    v_mfma_f32_16x16x32_bf16 v[44:47], v[80:83], v[76:79], v[44:47]
    ds_read_b64_tr_b16 v[118:119], v13 offset:8960
    v_mfma_f32_16x16x32_bf16 v[20:23], v[84:87], v[72:75], v[20:23]
    ds_read_b64_tr_b16 v[120:121], v13 offset:7200
    v_mfma_f32_16x16x32_bf16 v[48:51], v[84:87], v[76:79], v[48:51]
    ds_read_b64_tr_b16 v[122:123], v13 offset:8992
    v_mfma_f32_16x16x32_bf16 v[24:27], v[88:91], v[72:75], v[24:27]
    ds_read_b64_tr_b16 v[124:125], v13 offset:7232
    v_mfma_f32_16x16x32_bf16 v[52:55], v[88:91], v[76:79], v[52:55]
    ds_read_b64_tr_b16 v[126:127], v13 offset:9024
    v_mfma_f32_16x16x32_bf16 v[28:31], v[92:95], v[72:75], v[28:31]
    ds_read_b64_tr_b16 v[128:129], v13 offset:7264
    v_mfma_f32_16x16x32_bf16 v[56:59], v[92:95], v[76:79], v[56:59]
    ds_read_b64_tr_b16 v[130:131], v13 offset:9056
    v_mfma_f32_16x16x32_bf16 v[32:35], v[96:99], v[72:75], v[32:35]
    ds_read_b64_tr_b16 v[132:133], v13 offset:7296
    v_mfma_f32_16x16x32_bf16 v[60:63], v[96:99], v[76:79], v[60:63]
    ds_read_b64_tr_b16 v[134:135], v13 offset:9088
    v_mfma_f32_16x16x32_bf16 v[36:39], v[100:103], v[72:75], v[36:39]
    ds_read_b64_tr_b16 v[136:137], v13 offset:7328
    v_mfma_f32_16x16x32_bf16 v[64:67], v[100:103], v[76:79], v[64:67]
    ds_read_b64_tr_b16 v[138:139], v13 offset:9120
    v_mfma_f32_16x16x32_bf16 v[40:43], v[104:107], v[72:75], v[40:43]
    ds_read_b64_tr_b16 v[140:141], v13 offset:7360
    v_mfma_f32_16x16x32_bf16 v[68:71], v[104:107], v[76:79], v[68:71]
    ds_read_b64_tr_b16 v[142:143], v13 offset:9152
    v_add_u32 v9, s70, v6
    v_add_u32 v10, s70, v11
    s_waitcnt lgkmcnt(0)
    s_barrier
    ds_read_b128 v[72:75], v9
    ds_read_b128 v[76:79], v9 offset:2048
    v_mfma_f32_16x16x32_bf16 v[16:19], v[116:119], v[108:111], v[16:19]
    ds_read_b64_tr_b16 v[80:81], v10 offset:0
    v_mfma_f32_16x16x32_bf16 v[44:47], v[116:119], v[112:115], v[44:47]
    ds_read_b64_tr_b16 v[82:83], v10 offset:1792
    v_mfma_f32_16x16x32_bf16 v[20:23], v[120:123], v[108:111], v[20:23]
    ds_read_b64_tr_b16 v[84:85], v10 offset:32
    v_mfma_f32_16x16x32_bf16 v[48:51], v[120:123], v[112:115], v[48:51]
    ds_read_b64_tr_b16 v[86:87], v10 offset:1824
    v_mfma_f32_16x16x32_bf16 v[24:27], v[124:127], v[108:111], v[24:27]
    ds_read_b64_tr_b16 v[88:89], v10 offset:64
    v_mfma_f32_16x16x32_bf16 v[52:55], v[124:127], v[112:115], v[52:55]
    ds_read_b64_tr_b16 v[90:91], v10 offset:1856
    v_mfma_f32_16x16x32_bf16 v[28:31], v[128:131], v[108:111], v[28:31]
    ds_read_b64_tr_b16 v[92:93], v10 offset:96
    v_mfma_f32_16x16x32_bf16 v[56:59], v[128:131], v[112:115], v[56:59]
    ds_read_b64_tr_b16 v[94:95], v10 offset:1888
    v_mfma_f32_16x16x32_bf16 v[32:35], v[132:135], v[108:111], v[32:35]
    ds_read_b64_tr_b16 v[96:97], v10 offset:128
    v_mfma_f32_16x16x32_bf16 v[60:63], v[132:135], v[112:115], v[60:63]
    ds_read_b64_tr_b16 v[98:99], v10 offset:1920
    v_mfma_f32_16x16x32_bf16 v[36:39], v[136:139], v[108:111], v[36:39]
    ds_read_b64_tr_b16 v[100:101], v10 offset:160
    v_mfma_f32_16x16x32_bf16 v[64:67], v[136:139], v[112:115], v[64:67]
    ds_read_b64_tr_b16 v[102:103], v10 offset:1952
    v_mfma_f32_16x16x32_bf16 v[40:43], v[140:143], v[108:111], v[40:43]
    ds_read_b64_tr_b16 v[104:105], v10 offset:192
    v_mfma_f32_16x16x32_bf16 v[68:71], v[140:143], v[112:115], v[68:71]
    ds_read_b64_tr_b16 v[106:107], v10 offset:1984
    v_add_u32 v12, s70, v7
    v_add_u32 v13, s70, v11
    s_add_u32 s70, s70, 30720
    s_cmp_ge_u32 s70, 153600
    s_cselect_b32 s70, 0, s70
    s_waitcnt lgkmcnt(0)
    ds_read_b128 v[108:111], v12
    ds_read_b128 v[112:115], v12 offset:2048
    v_mfma_f32_16x16x32_bf16 v[16:19], v[80:83], v[72:75], v[16:19]
    ds_read_b64_tr_b16 v[116:117], v13 offset:7168
    v_mfma_f32_16x16x32_bf16 v[44:47], v[80:83], v[76:79], v[44:47]
    ds_read_b64_tr_b16 v[118:119], v13 offset:8960
    v_mfma_f32_16x16x32_bf16 v[20:23], v[84:87], v[72:75], v[20:23]
    ds_read_b64_tr_b16 v[120:121], v13 offset:7200
    v_mfma_f32_16x16x32_bf16 v[48:51], v[84:87], v[76:79], v[48:51]
    ds_read_b64_tr_b16 v[122:123], v13 offset:8992
    v_mfma_f32_16x16x32_bf16 v[24:27], v[88:91], v[72:75], v[24:27]
    ds_read_b64_tr_b16 v[124:125], v13 offset:7232
    v_mfma_f32_16x16x32_bf16 v[52:55], v[88:91], v[76:79], v[52:55]
    ds_read_b64_tr_b16 v[126:127], v13 offset:9024
    v_mfma_f32_16x16x32_bf16 v[28:31], v[92:95], v[72:75], v[28:31]
    ds_read_b64_tr_b16 v[128:129], v13 offset:7264
    v_mfma_f32_16x16x32_bf16 v[56:59], v[92:95], v[76:79], v[56:59]
    ds_read_b64_tr_b16 v[130:131], v13 offset:9056
    v_mfma_f32_16x16x32_bf16 v[32:35], v[96:99], v[72:75], v[32:35]
    ds_read_b64_tr_b16 v[132:133], v13 offset:7296
    v_mfma_f32_16x16x32_bf16 v[60:63], v[96:99], v[76:79], v[60:63]
    ds_read_b64_tr_b16 v[134:135], v13 offset:9088
    v_mfma_f32_16x16x32_bf16 v[36:39], v[100:103], v[72:75], v[36:39]
    ds_read_b64_tr_b16 v[136:137], v13 offset:7328
    v_mfma_f32_16x16x32_bf16 v[64:67], v[100:103], v[76:79], v[64:67]
    ds_read_b64_tr_b16 v[138:139], v13 offset:9120
    v_mfma_f32_16x16x32_bf16 v[40:43], v[104:107], v[72:75], v[40:43]
    ds_read_b64_tr_b16 v[140:141], v13 offset:7360
    v_mfma_f32_16x16x32_bf16 v[68:71], v[104:107], v[76:79], v[68:71]
    ds_read_b64_tr_b16 v[142:143], v13 offset:9152
    v_add_u32 v9, s70, v6
    v_add_u32 v10, s70, v11
    s_waitcnt lgkmcnt(0)
    s_barrier
    v_mov_b32 v3, 0
    v_mov_b32 v4, 1
    s_waitcnt vmcnt(0)
    s_mov_b64 exec, 1
    buffer_store_dword v4, v3, s[32:35], s74 offen sc0 sc1
    s_mov_b64 exec, -1
    ds_read_b128 v[72:75], v9
    ds_read_b128 v[76:79], v9 offset:2048
    v_mfma_f32_16x16x32_bf16 v[16:19], v[116:119], v[108:111], v[16:19]
    ds_read_b64_tr_b16 v[80:81], v10 offset:0
    v_mfma_f32_16x16x32_bf16 v[44:47], v[116:119], v[112:115], v[44:47]
    ds_read_b64_tr_b16 v[82:83], v10 offset:1792
    v_mfma_f32_16x16x32_bf16 v[20:23], v[120:123], v[108:111], v[20:23]
    ds_read_b64_tr_b16 v[84:85], v10 offset:32
    v_mfma_f32_16x16x32_bf16 v[48:51], v[120:123], v[112:115], v[48:51]
    ds_read_b64_tr_b16 v[86:87], v10 offset:1824
    v_mfma_f32_16x16x32_bf16 v[24:27], v[124:127], v[108:111], v[24:27]
    ds_read_b64_tr_b16 v[88:89], v10 offset:64
    v_mfma_f32_16x16x32_bf16 v[52:55], v[124:127], v[112:115], v[52:55]
    ds_read_b64_tr_b16 v[90:91], v10 offset:1856
    v_mfma_f32_16x16x32_bf16 v[28:31], v[128:131], v[108:111], v[28:31]
    ds_read_b64_tr_b16 v[92:93], v10 offset:96
    v_mfma_f32_16x16x32_bf16 v[56:59], v[128:131], v[112:115], v[56:59]
    ds_read_b64_tr_b16 v[94:95], v10 offset:1888
    v_mfma_f32_16x16x32_bf16 v[32:35], v[132:135], v[108:111], v[32:35]
    ds_read_b64_tr_b16 v[96:97], v10 offset:128
    v_mfma_f32_16x16x32_bf16 v[60:63], v[132:135], v[112:115], v[60:63]
    ds_read_b64_tr_b16 v[98:99], v10 offset:1920
    v_mfma_f32_16x16x32_bf16 v[36:39], v[136:139], v[108:111], v[36:39]
    ds_read_b64_tr_b16 v[100:101], v10 offset:160
    v_mfma_f32_16x16x32_bf16 v[64:67], v[136:139], v[112:115], v[64:67]
    ds_read_b64_tr_b16 v[102:103], v10 offset:1952
    v_mfma_f32_16x16x32_bf16 v[40:43], v[140:143], v[108:111], v[40:43]
    ds_read_b64_tr_b16 v[104:105], v10 offset:192
    v_mfma_f32_16x16x32_bf16 v[68:71], v[140:143], v[112:115], v[68:71]
    ds_read_b64_tr_b16 v[106:107], v10 offset:1984
    v_add_u32 v12, s70, v7
    v_add_u32 v13, s70, v11
    s_add_u32 s70, s70, 30720
    s_cmp_ge_u32 s70, 153600
    s_cselect_b32 s70, 0, s70
    s_waitcnt lgkmcnt(0)
    ds_read_b128 v[108:111], v12
    ds_read_b128 v[112:115], v12 offset:2048
    v_mfma_f32_16x16x32_bf16 v[16:19], v[80:83], v[72:75], v[16:19]
    ds_read_b64_tr_b16 v[116:117], v13 offset:7168
    v_mfma_f32_16x16x32_bf16 v[44:47], v[80:83], v[76:79], v[44:47]
    ds_read_b64_tr_b16 v[118:119], v13 offset:8960
    v_mfma_f32_16x16x32_bf16 v[20:23], v[84:87], v[72:75], v[20:23]
    ds_read_b64_tr_b16 v[120:121], v13 offset:7200
    v_mfma_f32_16x16x32_bf16 v[48:51], v[84:87], v[76:79], v[48:51]
    ds_read_b64_tr_b16 v[122:123], v13 offset:8992
    v_mfma_f32_16x16x32_bf16 v[24:27], v[88:91], v[72:75], v[24:27]
    ds_read_b64_tr_b16 v[124:125], v13 offset:7232
    v_mfma_f32_16x16x32_bf16 v[52:55], v[88:91], v[76:79], v[52:55]
    ds_read_b64_tr_b16 v[126:127], v13 offset:9024
    v_mfma_f32_16x16x32_bf16 v[28:31], v[92:95], v[72:75], v[28:31]
    ds_read_b64_tr_b16 v[128:129], v13 offset:7264
    v_mfma_f32_16x16x32_bf16 v[56:59], v[92:95], v[76:79], v[56:59]
    ds_read_b64_tr_b16 v[130:131], v13 offset:9056
    v_mfma_f32_16x16x32_bf16 v[32:35], v[96:99], v[72:75], v[32:35]
    ds_read_b64_tr_b16 v[132:133], v13 offset:7296
    v_mfma_f32_16x16x32_bf16 v[60:63], v[96:99], v[76:79], v[60:63]
    ds_read_b64_tr_b16 v[134:135], v13 offset:9088
    v_mfma_f32_16x16x32_bf16 v[36:39], v[100:103], v[72:75], v[36:39]
    ds_read_b64_tr_b16 v[136:137], v13 offset:7328
    v_mfma_f32_16x16x32_bf16 v[64:67], v[100:103], v[76:79], v[64:67]
    ds_read_b64_tr_b16 v[138:139], v13 offset:9120
    v_mfma_f32_16x16x32_bf16 v[40:43], v[104:107], v[72:75], v[40:43]
    ds_read_b64_tr_b16 v[140:141], v13 offset:7360
    v_mfma_f32_16x16x32_bf16 v[68:71], v[104:107], v[76:79], v[68:71]
    ds_read_b64_tr_b16 v[142:143], v13 offset:9152
    v_add_u32 v9, s70, v6
    v_add_u32 v10, s70, v11
    s_waitcnt lgkmcnt(0)
    s_barrier
    ds_read_b128 v[72:75], v9
    ds_read_b128 v[76:79], v9 offset:2048
    v_mfma_f32_16x16x32_bf16 v[16:19], v[116:119], v[108:111], v[16:19]
    ds_read_b64_tr_b16 v[80:81], v10 offset:0
    v_mfma_f32_16x16x32_bf16 v[44:47], v[116:119], v[112:115], v[44:47]
    ds_read_b64_tr_b16 v[82:83], v10 offset:1792
    v_mfma_f32_16x16x32_bf16 v[20:23], v[120:123], v[108:111], v[20:23]
    ds_read_b64_tr_b16 v[84:85], v10 offset:32
    v_mfma_f32_16x16x32_bf16 v[48:51], v[120:123], v[112:115], v[48:51]
    ds_read_b64_tr_b16 v[86:87], v10 offset:1824
    v_mfma_f32_16x16x32_bf16 v[24:27], v[124:127], v[108:111], v[24:27]
    ds_read_b64_tr_b16 v[88:89], v10 offset:64
    v_mfma_f32_16x16x32_bf16 v[52:55], v[124:127], v[112:115], v[52:55]
    ds_read_b64_tr_b16 v[90:91], v10 offset:1856
    v_mfma_f32_16x16x32_bf16 v[28:31], v[128:131], v[108:111], v[28:31]
    ds_read_b64_tr_b16 v[92:93], v10 offset:96
    v_mfma_f32_16x16x32_bf16 v[56:59], v[128:131], v[112:115], v[56:59]
    ds_read_b64_tr_b16 v[94:95], v10 offset:1888
    v_mfma_f32_16x16x32_bf16 v[32:35], v[132:135], v[108:111], v[32:35]
    ds_read_b64_tr_b16 v[96:97], v10 offset:128
    v_mfma_f32_16x16x32_bf16 v[60:63], v[132:135], v[112:115], v[60:63]
    ds_read_b64_tr_b16 v[98:99], v10 offset:1920
    v_mfma_f32_16x16x32_bf16 v[36:39], v[136:139], v[108:111], v[36:39]
    ds_read_b64_tr_b16 v[100:101], v10 offset:160
    v_mfma_f32_16x16x32_bf16 v[64:67], v[136:139], v[112:115], v[64:67]
    ds_read_b64_tr_b16 v[102:103], v10 offset:1952
    v_mfma_f32_16x16x32_bf16 v[40:43], v[140:143], v[108:111], v[40:43]
    ds_read_b64_tr_b16 v[104:105], v10 offset:192
    v_mfma_f32_16x16x32_bf16 v[68:71], v[140:143], v[112:115], v[68:71]
    ds_read_b64_tr_b16 v[106:107], v10 offset:1984
    s_waitcnt lgkmcnt(0)
    s_nop 7
    v_pk_mul_f32 v[72:73], v[16:17], v[16:17]
    v_pk_mul_f32 v[74:75], v[18:19], v[18:19]
    v_pk_mul_f32 v[76:77], v[20:21], v[20:21]
    v_pk_mul_f32 v[78:79], v[22:23], v[22:23]
    v_pk_mul_f32 v[80:81], v[24:25], v[24:25]
    v_pk_mul_f32 v[82:83], v[26:27], v[26:27]
    v_pk_mul_f32 v[84:85], v[28:29], v[28:29]
    v_pk_fma_f32 v[72:73], v[72:73], v[232:233], v[234:235]
    v_pk_fma_f32 v[74:75], v[74:75], v[232:233], v[234:235]
    v_pk_fma_f32 v[76:77], v[76:77], v[232:233], v[234:235]
    v_pk_fma_f32 v[78:79], v[78:79], v[232:233], v[234:235]
    v_pk_fma_f32 v[80:81], v[80:81], v[232:233], v[234:235]
    v_pk_fma_f32 v[82:83], v[82:83], v[232:233], v[234:235]
    v_pk_fma_f32 v[84:85], v[84:85], v[232:233], v[234:235]
    v_pk_mul_f32 v[72:73], v[72:73], v[16:17]
    v_pk_mul_f32 v[74:75], v[74:75], v[18:19]
    v_pk_mul_f32 v[76:77], v[76:77], v[20:21]
    v_pk_mul_f32 v[78:79], v[78:79], v[22:23]
    v_pk_mul_f32 v[80:81], v[80:81], v[24:25]
    v_pk_mul_f32 v[82:83], v[82:83], v[26:27]
    v_pk_mul_f32 v[84:85], v[84:85], v[28:29]
    v_exp_f32 v72, v72
    v_exp_f32 v73, v73
    v_exp_f32 v74, v74
    v_exp_f32 v75, v75
    v_exp_f32 v76, v76
    v_exp_f32 v77, v77
    v_exp_f32 v78, v78
    v_exp_f32 v79, v79
    v_exp_f32 v80, v80
    v_exp_f32 v81, v81
    v_exp_f32 v82, v82
    v_exp_f32 v83, v83
    v_exp_f32 v84, v84
    v_exp_f32 v85, v85
    v_pk_add_f32 v[72:73], v[72:73], 1.0 op_sel_hi:[1,0]
    v_pk_add_f32 v[74:75], v[74:75], 1.0 op_sel_hi:[1,0]
    v_pk_add_f32 v[76:77], v[76:77], 1.0 op_sel_hi:[1,0]
    v_pk_add_f32 v[78:79], v[78:79], 1.0 op_sel_hi:[1,0]
    v_pk_add_f32 v[80:81], v[80:81], 1.0 op_sel_hi:[1,0]
    v_pk_add_f32 v[82:83], v[82:83], 1.0 op_sel_hi:[1,0]
    v_pk_add_f32 v[84:85], v[84:85], 1.0 op_sel_hi:[1,0]
    v_rcp_f32 v72, v72
    v_rcp_f32 v73, v73
    v_rcp_f32 v74, v74
    v_rcp_f32 v75, v75
    v_rcp_f32 v76, v76
    v_rcp_f32 v77, v77
    v_rcp_f32 v78, v78
    v_rcp_f32 v79, v79
    v_rcp_f32 v80, v80
    v_rcp_f32 v81, v81
    v_rcp_f32 v82, v82
    v_rcp_f32 v83, v83
    v_rcp_f32 v84, v84
    v_rcp_f32 v85, v85
    v_pk_mul_f32 v[16:17], v[16:17], v[72:73]
    v_pk_mul_f32 v[18:19], v[18:19], v[74:75]
    v_pk_mul_f32 v[20:21], v[20:21], v[76:77]
    v_pk_mul_f32 v[22:23], v[22:23], v[78:79]
    v_pk_mul_f32 v[24:25], v[24:25], v[80:81]
    v_pk_mul_f32 v[26:27], v[26:27], v[82:83]
    v_pk_mul_f32 v[28:29], v[28:29], v[84:85]
    v_pk_mul_f32 v[72:73], v[30:31], v[30:31]
    v_pk_mul_f32 v[74:75], v[32:33], v[32:33]
    v_pk_mul_f32 v[76:77], v[34:35], v[34:35]
    v_pk_mul_f32 v[78:79], v[36:37], v[36:37]
    v_pk_mul_f32 v[80:81], v[38:39], v[38:39]
    v_pk_mul_f32 v[82:83], v[40:41], v[40:41]
    v_pk_mul_f32 v[84:85], v[42:43], v[42:43]
    v_pk_fma_f32 v[72:73], v[72:73], v[232:233], v[234:235]
    v_pk_fma_f32 v[74:75], v[74:75], v[232:233], v[234:235]
    v_pk_fma_f32 v[76:77], v[76:77], v[232:233], v[234:235]
    v_pk_fma_f32 v[78:79], v[78:79], v[232:233], v[234:235]
    v_pk_fma_f32 v[80:81], v[80:81], v[232:233], v[234:235]
    v_pk_fma_f32 v[82:83], v[82:83], v[232:233], v[234:235]
    v_pk_fma_f32 v[84:85], v[84:85], v[232:233], v[234:235]
    v_pk_mul_f32 v[72:73], v[72:73], v[30:31]
    v_pk_mul_f32 v[74:75], v[74:75], v[32:33]
    v_pk_mul_f32 v[76:77], v[76:77], v[34:35]
    v_pk_mul_f32 v[78:79], v[78:79], v[36:37]
    v_pk_mul_f32 v[80:81], v[80:81], v[38:39]
    v_pk_mul_f32 v[82:83], v[82:83], v[40:41]
    v_pk_mul_f32 v[84:85], v[84:85], v[42:43]
    v_exp_f32 v72, v72
    v_exp_f32 v73, v73
    v_exp_f32 v74, v74
    v_exp_f32 v75, v75
    v_exp_f32 v76, v76
    v_exp_f32 v77, v77
    v_exp_f32 v78, v78
    v_exp_f32 v79, v79
    v_exp_f32 v80, v80
    v_exp_f32 v81, v81
    v_exp_f32 v82, v82
    v_exp_f32 v83, v83
    v_exp_f32 v84, v84
    v_exp_f32 v85, v85
    v_pk_add_f32 v[72:73], v[72:73], 1.0 op_sel_hi:[1,0]
    v_pk_add_f32 v[74:75], v[74:75], 1.0 op_sel_hi:[1,0]
    v_pk_add_f32 v[76:77], v[76:77], 1.0 op_sel_hi:[1,0]
    v_pk_add_f32 v[78:79], v[78:79], 1.0 op_sel_hi:[1,0]
    v_pk_add_f32 v[80:81], v[80:81], 1.0 op_sel_hi:[1,0]
    v_pk_add_f32 v[82:83], v[82:83], 1.0 op_sel_hi:[1,0]
    v_pk_add_f32 v[84:85], v[84:85], 1.0 op_sel_hi:[1,0]
    v_rcp_f32 v72, v72
    v_rcp_f32 v73, v73
    v_rcp_f32 v74, v74
    v_rcp_f32 v75, v75
    v_rcp_f32 v76, v76
    v_rcp_f32 v77, v77
    v_rcp_f32 v78, v78
    v_rcp_f32 v79, v79
    v_rcp_f32 v80, v80
    v_rcp_f32 v81, v81
    v_rcp_f32 v82, v82
    v_rcp_f32 v83, v83
    v_rcp_f32 v84, v84
    v_rcp_f32 v85, v85
    v_pk_mul_f32 v[30:31], v[30:31], v[72:73]
    v_pk_mul_f32 v[32:33], v[32:33], v[74:75]
    v_pk_mul_f32 v[34:35], v[34:35], v[76:77]
    v_pk_mul_f32 v[36:37], v[36:37], v[78:79]
    v_pk_mul_f32 v[38:39], v[38:39], v[80:81]
    v_pk_mul_f32 v[40:41], v[40:41], v[82:83]
    v_pk_mul_f32 v[42:43], v[42:43], v[84:85]
    v_pk_mul_f32 v[72:73], v[44:45], v[44:45]
    v_pk_mul_f32 v[74:75], v[46:47], v[46:47]
    v_pk_mul_f32 v[76:77], v[48:49], v[48:49]
    v_pk_mul_f32 v[78:79], v[50:51], v[50:51]
    v_pk_mul_f32 v[80:81], v[52:53], v[52:53]
    v_pk_mul_f32 v[82:83], v[54:55], v[54:55]
    v_pk_mul_f32 v[84:85], v[56:57], v[56:57]
    v_pk_fma_f32 v[72:73], v[72:73], v[232:233], v[234:235]
    v_pk_fma_f32 v[74:75], v[74:75], v[232:233], v[234:235]
    v_pk_fma_f32 v[76:77], v[76:77], v[232:233], v[234:235]
    v_pk_fma_f32 v[78:79], v[78:79], v[232:233], v[234:235]
    v_pk_fma_f32 v[80:81], v[80:81], v[232:233], v[234:235]
    v_pk_fma_f32 v[82:83], v[82:83], v[232:233], v[234:235]
    v_pk_fma_f32 v[84:85], v[84:85], v[232:233], v[234:235]
    v_pk_mul_f32 v[72:73], v[72:73], v[44:45]
    v_pk_mul_f32 v[74:75], v[74:75], v[46:47]
    v_pk_mul_f32 v[76:77], v[76:77], v[48:49]
    v_pk_mul_f32 v[78:79], v[78:79], v[50:51]
    v_pk_mul_f32 v[80:81], v[80:81], v[52:53]
    v_pk_mul_f32 v[82:83], v[82:83], v[54:55]
    v_pk_mul_f32 v[84:85], v[84:85], v[56:57]
    v_exp_f32 v72, v72
    v_exp_f32 v73, v73
    v_exp_f32 v74, v74
    v_exp_f32 v75, v75
    v_exp_f32 v76, v76
    v_exp_f32 v77, v77
    v_exp_f32 v78, v78
    v_exp_f32 v79, v79
    v_exp_f32 v80, v80
    v_exp_f32 v81, v81
    v_exp_f32 v82, v82
    v_exp_f32 v83, v83
    v_exp_f32 v84, v84
    v_exp_f32 v85, v85
    v_pk_add_f32 v[72:73], v[72:73], 1.0 op_sel_hi:[1,0]
    v_pk_add_f32 v[74:75], v[74:75], 1.0 op_sel_hi:[1,0]
    v_pk_add_f32 v[76:77], v[76:77], 1.0 op_sel_hi:[1,0]
    v_pk_add_f32 v[78:79], v[78:79], 1.0 op_sel_hi:[1,0]
    v_pk_add_f32 v[80:81], v[80:81], 1.0 op_sel_hi:[1,0]
    v_pk_add_f32 v[82:83], v[82:83], 1.0 op_sel_hi:[1,0]
    v_pk_add_f32 v[84:85], v[84:85], 1.0 op_sel_hi:[1,0]
    v_rcp_f32 v72, v72
    v_rcp_f32 v73, v73
    v_rcp_f32 v74, v74
    v_rcp_f32 v75, v75
    v_rcp_f32 v76, v76
    v_rcp_f32 v77, v77
    v_rcp_f32 v78, v78
    v_rcp_f32 v79, v79
    v_rcp_f32 v80, v80
    v_rcp_f32 v81, v81
    v_rcp_f32 v82, v82
    v_rcp_f32 v83, v83
    v_rcp_f32 v84, v84
    v_rcp_f32 v85, v85
    v_pk_mul_f32 v[44:45], v[44:45], v[72:73]
    v_pk_mul_f32 v[46:47], v[46:47], v[74:75]
    v_pk_mul_f32 v[48:49], v[48:49], v[76:77]
    v_pk_mul_f32 v[50:51], v[50:51], v[78:79]
    v_pk_mul_f32 v[52:53], v[52:53], v[80:81]
    v_pk_mul_f32 v[54:55], v[54:55], v[82:83]
    v_pk_mul_f32 v[56:57], v[56:57], v[84:85]
    v_pk_mul_f32 v[72:73], v[58:59], v[58:59]
    v_pk_mul_f32 v[74:75], v[60:61], v[60:61]
    v_pk_mul_f32 v[76:77], v[62:63], v[62:63]
    v_pk_mul_f32 v[78:79], v[64:65], v[64:65]
    v_pk_mul_f32 v[80:81], v[66:67], v[66:67]
    v_pk_mul_f32 v[82:83], v[68:69], v[68:69]
    v_pk_mul_f32 v[84:85], v[70:71], v[70:71]
    v_pk_fma_f32 v[72:73], v[72:73], v[232:233], v[234:235]
    v_pk_fma_f32 v[74:75], v[74:75], v[232:233], v[234:235]
    v_pk_fma_f32 v[76:77], v[76:77], v[232:233], v[234:235]
    v_pk_fma_f32 v[78:79], v[78:79], v[232:233], v[234:235]
    v_pk_fma_f32 v[80:81], v[80:81], v[232:233], v[234:235]
    v_pk_fma_f32 v[82:83], v[82:83], v[232:233], v[234:235]
    v_pk_fma_f32 v[84:85], v[84:85], v[232:233], v[234:235]
    v_pk_mul_f32 v[72:73], v[72:73], v[58:59]
    v_pk_mul_f32 v[74:75], v[74:75], v[60:61]
    v_pk_mul_f32 v[76:77], v[76:77], v[62:63]
    v_pk_mul_f32 v[78:79], v[78:79], v[64:65]
    v_pk_mul_f32 v[80:81], v[80:81], v[66:67]
    v_pk_mul_f32 v[82:83], v[82:83], v[68:69]
    v_pk_mul_f32 v[84:85], v[84:85], v[70:71]
    v_exp_f32 v72, v72
    v_exp_f32 v73, v73
    v_exp_f32 v74, v74
    v_exp_f32 v75, v75
    v_exp_f32 v76, v76
    v_exp_f32 v77, v77
    v_exp_f32 v78, v78
    v_exp_f32 v79, v79
    v_exp_f32 v80, v80
    v_exp_f32 v81, v81
    v_exp_f32 v82, v82
    v_exp_f32 v83, v83
    v_exp_f32 v84, v84
    v_exp_f32 v85, v85
    v_pk_add_f32 v[72:73], v[72:73], 1.0 op_sel_hi:[1,0]
    v_pk_add_f32 v[74:75], v[74:75], 1.0 op_sel_hi:[1,0]
    v_pk_add_f32 v[76:77], v[76:77], 1.0 op_sel_hi:[1,0]
    v_pk_add_f32 v[78:79], v[78:79], 1.0 op_sel_hi:[1,0]
    v_pk_add_f32 v[80:81], v[80:81], 1.0 op_sel_hi:[1,0]
    v_pk_add_f32 v[82:83], v[82:83], 1.0 op_sel_hi:[1,0]
    v_pk_add_f32 v[84:85], v[84:85], 1.0 op_sel_hi:[1,0]
    v_rcp_f32 v72, v72
    v_rcp_f32 v73, v73
    v_rcp_f32 v74, v74
    v_rcp_f32 v75, v75
    v_rcp_f32 v76, v76
    v_rcp_f32 v77, v77
    v_rcp_f32 v78, v78
    v_rcp_f32 v79, v79
    v_rcp_f32 v80, v80
    v_rcp_f32 v81, v81
    v_rcp_f32 v82, v82
    v_rcp_f32 v83, v83
    v_rcp_f32 v84, v84
    v_rcp_f32 v85, v85
    v_pk_mul_f32 v[58:59], v[58:59], v[72:73]
    v_pk_mul_f32 v[60:61], v[60:61], v[74:75]
    v_pk_mul_f32 v[62:63], v[62:63], v[76:77]
    v_pk_mul_f32 v[64:65], v[64:65], v[78:79]
    v_pk_mul_f32 v[66:67], v[66:67], v[80:81]
    v_pk_mul_f32 v[68:69], v[68:69], v[82:83]
    v_pk_mul_f32 v[70:71], v[70:71], v[84:85]
    v_cvt_pk_bf16_f32 v144, v16, v17
    v_cvt_pk_bf16_f32 v145, v18, v19
    v_cvt_pk_bf16_f32 v146, v20, v21
    v_cvt_pk_bf16_f32 v147, v22, v23
    v_cvt_pk_bf16_f32 v148, v24, v25
    v_cvt_pk_bf16_f32 v149, v26, v27
    v_cvt_pk_bf16_f32 v150, v28, v29
    v_cvt_pk_bf16_f32 v151, v30, v31
    v_cvt_pk_bf16_f32 v152, v32, v33
    v_cvt_pk_bf16_f32 v153, v34, v35
    v_cvt_pk_bf16_f32 v154, v36, v37
    v_cvt_pk_bf16_f32 v155, v38, v39
    v_cvt_pk_bf16_f32 v156, v40, v41
    v_cvt_pk_bf16_f32 v157, v42, v43
    v_cvt_pk_bf16_f32 v158, v44, v45
    v_cvt_pk_bf16_f32 v159, v46, v47
    v_cvt_pk_bf16_f32 v160, v48, v49
    v_cvt_pk_bf16_f32 v161, v50, v51
    v_cvt_pk_bf16_f32 v162, v52, v53
    v_cvt_pk_bf16_f32 v163, v54, v55
    v_cvt_pk_bf16_f32 v164, v56, v57
    v_cvt_pk_bf16_f32 v165, v58, v59
    v_cvt_pk_bf16_f32 v166, v60, v61
    v_cvt_pk_bf16_f32 v167, v62, v63
    v_cvt_pk_bf16_f32 v168, v64, v65
    v_cvt_pk_bf16_f32 v169, v66, v67
    v_cvt_pk_bf16_f32 v170, v68, v69
    v_cvt_pk_bf16_f32 v171, v70, v71
    s_branch C_M
C_Y:
    v_add_u32 v11, 0x4000, v5
    v_xor_b32 v1, 64, v11
    v_mov_b32 v10, v11
    s_lshr_b32 s66, s57, 2
    s_and_b32 s66, s66, 1
    s_lshl_b32 s66, s66, 7
    s_add_u32 s66, s66, s64
    s_lshl_b32 s66, s66, 2
    s_and_b32 s67, s57, 3
    s_add_u32 s66, s66, s67
    s_mul_i32 s66, s66, 3584
    s_add_u32 s66, s66, 16777216
    s_add_u32 s67, s66, 14336
    s_waitcnt lgkmcnt(0)
    s_mov_b32 s32, s30
    s_and_b32 s33, s31, 0xffff
    s_mov_b32 s34, 23068672
    s_mov_b32 s35, 0x20000
    s_mov_b32 s36, s28
    s_and_b32 s37, s29, 0xffff
    s_mov_b32 s38, 256
    s_mov_b32 s39, 0x20000
    s_barrier
    ds_read_b128 v[72:75], v9
    ds_read_b128 v[76:79], v9 offset:2048
    ds_read_b128 v[80:83], v10 offset:0
    ds_read_b128 v[84:87], v10 offset:2048
    ds_read_b128 v[88:91], v10 offset:4096
    ds_read_b128 v[92:95], v10 offset:6144
    ds_read_b128 v[96:99], v10 offset:8192
    ds_read_b128 v[100:103], v10 offset:10240
    ds_read_b128 v[104:107], v10 offset:12288
.p2align 6
C_AB:
    v_add_u32 v12, s70, v7
    v_add_u32 v13, s70, v1
    s_add_u32 s70, s70, 30720
    s_cmp_ge_u32 s70, 153600
    s_cselect_b32 s70, 0, s70
    s_waitcnt lgkmcnt(0)
    v_mfma_f32_16x16x32_bf16 v[16:19], v[72:75], v[80:83], v[16:19]
    ds_read_b128 v[108:111], v12
    v_mfma_f32_16x16x32_bf16 v[20:23], v[76:79], v[80:83], v[20:23]
    ds_read_b128 v[112:115], v12 offset:2048
    v_mfma_f32_16x16x32_bf16 v[24:27], v[72:75], v[84:87], v[24:27]
    ds_read_b128 v[116:119], v13 offset:0
    v_mfma_f32_16x16x32_bf16 v[28:31], v[76:79], v[84:87], v[28:31]
    ds_read_b128 v[120:123], v13 offset:2048
    v_mfma_f32_16x16x32_bf16 v[32:35], v[72:75], v[88:91], v[32:35]
    ds_read_b128 v[124:127], v13 offset:4096
    v_mfma_f32_16x16x32_bf16 v[36:39], v[76:79], v[88:91], v[36:39]
    ds_read_b128 v[128:131], v13 offset:6144
    v_mfma_f32_16x16x32_bf16 v[40:43], v[72:75], v[92:95], v[40:43]
    ds_read_b128 v[132:135], v13 offset:8192
    v_mfma_f32_16x16x32_bf16 v[44:47], v[76:79], v[92:95], v[44:47]
    ds_read_b128 v[136:139], v13 offset:10240
    v_mfma_f32_16x16x32_bf16 v[48:51], v[72:75], v[96:99], v[48:51]
    ds_read_b128 v[140:143], v13 offset:12288
    v_mfma_f32_16x16x32_bf16 v[52:55], v[76:79], v[96:99], v[52:55]
    v_mfma_f32_16x16x32_bf16 v[56:59], v[72:75], v[100:103], v[56:59]
    v_mfma_f32_16x16x32_bf16 v[60:63], v[76:79], v[100:103], v[60:63]
    v_mfma_f32_16x16x32_bf16 v[64:67], v[72:75], v[104:107], v[64:67]
    v_mfma_f32_16x16x32_bf16 v[68:71], v[76:79], v[104:107], v[68:71]
    v_add_u32 v9, s70, v6
    v_add_u32 v10, s70, v11
    s_waitcnt lgkmcnt(0)
    s_barrier
    v_mfma_f32_16x16x32_bf16 v[16:19], v[108:111], v[116:119], v[16:19]
    ds_read_b128 v[72:75], v9
    v_mfma_f32_16x16x32_bf16 v[20:23], v[112:115], v[116:119], v[20:23]
    ds_read_b128 v[76:79], v9 offset:2048
    v_mfma_f32_16x16x32_bf16 v[24:27], v[108:111], v[120:123], v[24:27]
    ds_read_b128 v[80:83], v10 offset:0
    v_mfma_f32_16x16x32_bf16 v[28:31], v[112:115], v[120:123], v[28:31]
    ds_read_b128 v[84:87], v10 offset:2048
    v_mfma_f32_16x16x32_bf16 v[32:35], v[108:111], v[124:127], v[32:35]
    ds_read_b128 v[88:91], v10 offset:4096
    v_mfma_f32_16x16x32_bf16 v[36:39], v[112:115], v[124:127], v[36:39]
    ds_read_b128 v[92:95], v10 offset:6144
    v_mfma_f32_16x16x32_bf16 v[40:43], v[108:111], v[128:131], v[40:43]
    ds_read_b128 v[96:99], v10 offset:8192
    v_mfma_f32_16x16x32_bf16 v[44:47], v[112:115], v[128:131], v[44:47]
    ds_read_b128 v[100:103], v10 offset:10240
    v_mfma_f32_16x16x32_bf16 v[48:51], v[108:111], v[132:135], v[48:51]
    ds_read_b128 v[104:107], v10 offset:12288
    v_mfma_f32_16x16x32_bf16 v[52:55], v[112:115], v[132:135], v[52:55]
    v_mfma_f32_16x16x32_bf16 v[56:59], v[108:111], v[136:139], v[56:59]
    v_mfma_f32_16x16x32_bf16 v[60:63], v[112:115], v[136:139], v[60:63]
    v_mfma_f32_16x16x32_bf16 v[64:67], v[108:111], v[140:143], v[64:67]
    v_mfma_f32_16x16x32_bf16 v[68:71], v[112:115], v[140:143], v[68:71]
    s_add_u32 s71, s71, 1
    s_cmp_lt_u32 s71, 7
    s_cbranch_scc1 C_AB
    s_nop 7
    v_cvt_pk_bf16_f32 v176, v16, v17
    v_cvt_pk_bf16_f32 v177, v18, v19
    v_cvt_pk_bf16_f32 v178, v20, v21
    v_cvt_pk_bf16_f32 v179, v22, v23
    v_cvt_pk_bf16_f32 v180, v24, v25
    v_cvt_pk_bf16_f32 v181, v26, v27
    v_cvt_pk_bf16_f32 v182, v28, v29
    v_cvt_pk_bf16_f32 v183, v30, v31
    v_cvt_pk_bf16_f32 v184, v32, v33
    v_cvt_pk_bf16_f32 v185, v34, v35
    v_cvt_pk_bf16_f32 v186, v36, v37
    v_cvt_pk_bf16_f32 v187, v38, v39
    v_cvt_pk_bf16_f32 v188, v40, v41
    v_cvt_pk_bf16_f32 v189, v42, v43
    v_cvt_pk_bf16_f32 v190, v44, v45
    v_cvt_pk_bf16_f32 v191, v46, v47
    v_cvt_pk_bf16_f32 v192, v48, v49
    v_cvt_pk_bf16_f32 v193, v50, v51
    v_cvt_pk_bf16_f32 v194, v52, v53
    v_cvt_pk_bf16_f32 v195, v54, v55
    v_cvt_pk_bf16_f32 v196, v56, v57
    v_cvt_pk_bf16_f32 v197, v58, v59
    v_cvt_pk_bf16_f32 v198, v60, v61
    v_cvt_pk_bf16_f32 v199, v62, v63
    v_cvt_pk_bf16_f32 v200, v64, v65
    v_cvt_pk_bf16_f32 v201, v66, v67
    v_cvt_pk_bf16_f32 v202, v68, v69
    v_cvt_pk_bf16_f32 v203, v70, v71
    buffer_store_dwordx4 v[176:179], v14, s[32:35], s73 offen offset:0 sc0 sc1
    buffer_store_dwordx4 v[180:183], v14, s[32:35], s73 offen offset:1024 sc0 sc1
    buffer_store_dwordx4 v[184:187], v14, s[32:35], s73 offen offset:2048 sc0 sc1
    buffer_store_dwordx4 v[188:191], v14, s[32:35], s73 offen offset:3072 sc0 sc1
    buffer_store_dwordx4 v[192:195], v14, s[32:35], s77 offen offset:0 sc0 sc1
    buffer_store_dwordx4 v[196:199], v14, s[32:35], s77 offen offset:1024 sc0 sc1
    buffer_store_dwordx4 v[200:203], v14, s[32:35], s77 offen offset:2048 sc0 sc1
    v_mov_b32 v3, 0
    v_mov_b32 v4, 1
    s_waitcnt vmcnt(0)
    s_mov_b64 exec, 1
    buffer_store_dword v4, v3, s[32:35], s74 offen sc0 sc1
    s_mov_b64 exec, -1
C_M:
    v_mov_b32 v16, 0
    v_mov_b32 v17, 0
    v_mov_b32 v18, 0
    v_mov_b32 v19, 0
    v_mov_b32 v20, 0
    v_mov_b32 v21, 0
    v_mov_b32 v22, 0
    v_mov_b32 v23, 0
    v_mov_b32 v24, 0
    v_mov_b32 v25, 0
    v_mov_b32 v26, 0
    v_mov_b32 v27, 0
    v_mov_b32 v28, 0
    v_mov_b32 v29, 0
    v_mov_b32 v30, 0
    v_mov_b32 v31, 0
    v_mov_b32 v32, 0
    v_mov_b32 v33, 0
    v_mov_b32 v34, 0
    v_mov_b32 v35, 0
    v_mov_b32 v36, 0
    v_mov_b32 v37, 0
    v_mov_b32 v38, 0
    v_mov_b32 v39, 0
    v_mov_b32 v40, 0
    v_mov_b32 v41, 0
    v_mov_b32 v42, 0
    v_mov_b32 v43, 0
    v_mov_b32 v44, 0
    v_mov_b32 v45, 0
    v_mov_b32 v46, 0
    v_mov_b32 v47, 0
    v_mov_b32 v48, 0
    v_mov_b32 v49, 0
    v_mov_b32 v50, 0
    v_mov_b32 v51, 0
    v_mov_b32 v52, 0
    v_mov_b32 v53, 0
    v_mov_b32 v54, 0
    v_mov_b32 v55, 0
    v_mov_b32 v56, 0
    v_mov_b32 v57, 0
    v_mov_b32 v58, 0
    v_mov_b32 v59, 0
    v_mov_b32 v60, 0
    v_mov_b32 v61, 0
    v_mov_b32 v62, 0
    v_mov_b32 v63, 0
    v_mov_b32 v64, 0
    v_mov_b32 v65, 0
    v_mov_b32 v66, 0
    v_mov_b32 v67, 0
    v_mov_b32 v68, 0
    v_mov_b32 v69, 0
    v_mov_b32 v70, 0
    v_mov_b32 v71, 0
    v_add_u32 v10, s70, v8
    s_mov_b32 s71, 0
    s_waitcnt lgkmcnt(0)
    s_barrier
    ds_read_b128 v[72:75], v9
    ds_read_b128 v[76:79], v9 offset:2048
    ds_read_b128 v[80:83], v10 offset:0
    ds_read_b128 v[84:87], v10 offset:1024
    ds_read_b128 v[88:91], v10 offset:2048
    ds_read_b128 v[92:95], v10 offset:3072
    ds_read_b128 v[96:99], v10 offset:4096
    ds_read_b128 v[100:103], v10 offset:5120
    ds_read_b128 v[104:107], v10 offset:6144
    s_mov_b32 s79, 28
    s_waitcnt vmcnt(0)
.p2align 6
C_LOOP:
    v_add_u32 v12, s70, v7
    v_add_u32 v13, s70, v8
    s_add_u32 s70, s70, 30720
    s_cmp_ge_u32 s70, 153600
    s_cselect_b32 s70, 0, s70
    s_waitcnt lgkmcnt(0)
    v_mfma_f32_16x16x32_bf16 v[16:19], v[80:83], v[72:75], v[16:19]
    ds_read_b128 v[108:111], v12
    v_mfma_f32_16x16x32_bf16 v[44:47], v[80:83], v[76:79], v[44:47]
    ds_read_b128 v[112:115], v12 offset:2048
    v_mfma_f32_16x16x32_bf16 v[20:23], v[84:87], v[72:75], v[20:23]
    ds_read_b128 v[116:119], v13 offset:7168
    v_mfma_f32_16x16x32_bf16 v[48:51], v[84:87], v[76:79], v[48:51]
    ds_read_b128 v[120:123], v13 offset:8192
    v_mfma_f32_16x16x32_bf16 v[24:27], v[88:91], v[72:75], v[24:27]
    ds_read_b128 v[124:127], v13 offset:9216
    v_mfma_f32_16x16x32_bf16 v[52:55], v[88:91], v[76:79], v[52:55]
    ds_read_b128 v[128:131], v13 offset:10240
    v_mfma_f32_16x16x32_bf16 v[28:31], v[92:95], v[72:75], v[28:31]
    ds_read_b128 v[132:135], v13 offset:11264
    v_mfma_f32_16x16x32_bf16 v[56:59], v[92:95], v[76:79], v[56:59]
    ds_read_b128 v[136:139], v13 offset:12288
    v_mfma_f32_16x16x32_bf16 v[32:35], v[96:99], v[72:75], v[32:35]
    ds_read_b128 v[140:143], v13 offset:13312
    v_mfma_f32_16x16x32_bf16 v[60:63], v[96:99], v[76:79], v[60:63]
    v_mfma_f32_16x16x32_bf16 v[36:39], v[100:103], v[72:75], v[36:39]
    v_mfma_f32_16x16x32_bf16 v[64:67], v[100:103], v[76:79], v[64:67]
    v_mfma_f32_16x16x32_bf16 v[40:43], v[104:107], v[72:75], v[40:43]
    v_mfma_f32_16x16x32_bf16 v[68:71], v[104:107], v[76:79], v[68:71]
    v_add_u32 v9, s70, v6
    v_add_u32 v10, s70, v8
    s_waitcnt lgkmcnt(0)
    s_barrier
    v_mfma_f32_16x16x32_bf16 v[16:19], v[116:119], v[108:111], v[16:19]
    ds_read_b128 v[72:75], v9
    v_mfma_f32_16x16x32_bf16 v[44:47], v[116:119], v[112:115], v[44:47]
    ds_read_b128 v[76:79], v9 offset:2048
    v_mfma_f32_16x16x32_bf16 v[20:23], v[120:123], v[108:111], v[20:23]
    ds_read_b128 v[80:83], v10 offset:0
    v_mfma_f32_16x16x32_bf16 v[48:51], v[120:123], v[112:115], v[48:51]
    ds_read_b128 v[84:87], v10 offset:1024
    v_mfma_f32_16x16x32_bf16 v[24:27], v[124:127], v[108:111], v[24:27]
    ds_read_b128 v[88:91], v10 offset:2048
    v_mfma_f32_16x16x32_bf16 v[52:55], v[124:127], v[112:115], v[52:55]
    ds_read_b128 v[92:95], v10 offset:3072
    v_mfma_f32_16x16x32_bf16 v[28:31], v[128:131], v[108:111], v[28:31]
    ds_read_b128 v[96:99], v10 offset:4096
    v_mfma_f32_16x16x32_bf16 v[56:59], v[128:131], v[112:115], v[56:59]
    ds_read_b128 v[100:103], v10 offset:5120
    v_mfma_f32_16x16x32_bf16 v[32:35], v[132:135], v[108:111], v[32:35]
    ds_read_b128 v[104:107], v10 offset:6144
    v_mfma_f32_16x16x32_bf16 v[60:63], v[132:135], v[112:115], v[60:63]
    v_mfma_f32_16x16x32_bf16 v[36:39], v[136:139], v[108:111], v[36:39]
    v_mfma_f32_16x16x32_bf16 v[64:67], v[136:139], v[112:115], v[64:67]
    v_mfma_f32_16x16x32_bf16 v[40:43], v[140:143], v[108:111], v[40:43]
    v_mfma_f32_16x16x32_bf16 v[68:71], v[140:143], v[112:115], v[68:71]
    s_add_u32 s71, s71, 1
    s_cmp_lt_u32 s71, s79
    s_cbranch_scc1 C_LOOP
    s_cmp_eq_u32 s79, 32
    s_cbranch_scc1 C_DONE
    s_lshl_b32 s40, s58, 3
    s_lshr_b32 s41, s59, 2
    s_add_u32 s40, s40, s41
    s_and_b32 s41, s59, 3
    s_mul_i32 s42, s41, 196
    s_mul_i32 s43, s3, 7
    s_add_u32 s42, s42, s43
    s_lshl_b32 s42, s42, 10
    s_add_u32 s42, s42, 20971520
    v_lshlrev_b32 v14, 4, v2
    s_add_u32 s43, s42, 50176
    buffer_load_dwordx4 v[176:179], v14, s[32:35], s43 offen offset:1024 sc1
    buffer_load_dwordx4 v[180:183], v14, s[32:35], s43 offen offset:2048 sc1
    buffer_load_dwordx4 v[184:187], v14, s[32:35], s43 offen offset:3072 sc1
    s_add_u32 s43, s42, 54272
    buffer_load_dwordx4 v[188:191], v14, s[32:35], s43 offen offset:0 sc1
    buffer_load_dwordx4 v[192:195], v14, s[32:35], s43 offen offset:1024 sc1
    buffer_load_dwordx4 v[196:199], v14, s[32:35], s43 offen offset:2048 sc1
    s_add_u32 s43, s42, 100352
    buffer_load_dwordx4 v[200:203], v14, s[32:35], s43 offen offset:0 sc1
    buffer_load_dwordx4 v[204:207], v14, s[32:35], s43 offen offset:1024 sc1
    buffer_load_dwordx4 v[208:211], v14, s[32:35], s43 offen offset:2048 sc1
    buffer_load_dwordx4 v[212:215], v14, s[32:35], s43 offen offset:3072 sc1
    s_add_u32 s43, s42, 104448
    buffer_load_dwordx4 v[216:219], v14, s[32:35], s43 offen offset:0 sc1
    buffer_load_dwordx4 v[220:223], v14, s[32:35], s43 offen offset:1024 sc1
    buffer_load_dwordx4 v[224:227], v14, s[32:35], s43 offen offset:2048 sc1
    s_add_u32 s43, s42, 150528
    buffer_load_dwordx4 v[228:231], v14, s[32:35], s43 offen offset:0 sc1
    buffer_load_dwordx4 v[232:235], v14, s[32:35], s43 offen offset:1024 sc1
    buffer_load_dwordx4 v[236:239], v14, s[32:35], s43 offen offset:2048 sc1
    buffer_load_dwordx4 v[240:243], v14, s[32:35], s43 offen offset:3072 sc1
    s_add_u32 s43, s42, 154624
    buffer_load_dwordx4 v[244:247], v14, s[32:35], s43 offen offset:0 sc1
    buffer_load_dwordx4 v[248:251], v14, s[32:35], s43 offen offset:1024 sc1
    buffer_load_dwordx4 v[252:255], v14, s[32:35], s43 offen offset:2048 sc1
    s_mov_b32 s79, 32
    s_branch C_LOOP
C_DONE:
    s_waitcnt lgkmcnt(0)
    s_nop 4
    s_cmp_lt_u32 s58, 4
    s_cbranch_scc0 C_PACK
    v_lshlrev_b32 v172, 16, v172
    v_lshlrev_b32 v173, 16, v173
    v_lshlrev_b32 v72, 16, v144
    v_and_b32 v73, 0xffff0000, v144
    v_pk_add_f32 v[16:17], v[16:17], v[172:173] op_sel:[0,0] op_sel_hi:[1,0]
    v_pk_mul_f32 v[16:17], v[16:17], v[72:73]
    v_lshlrev_b32 v74, 16, v145
    v_and_b32 v75, 0xffff0000, v145
    v_pk_add_f32 v[18:19], v[18:19], v[172:173] op_sel:[0,0] op_sel_hi:[1,0]
    v_pk_mul_f32 v[18:19], v[18:19], v[74:75]
    v_lshlrev_b32 v76, 16, v146
    v_and_b32 v77, 0xffff0000, v146
    v_pk_add_f32 v[20:21], v[20:21], v[172:173] op_sel:[0,0] op_sel_hi:[1,0]
    v_pk_mul_f32 v[20:21], v[20:21], v[76:77]
    v_lshlrev_b32 v78, 16, v147
    v_and_b32 v79, 0xffff0000, v147
    v_pk_add_f32 v[22:23], v[22:23], v[172:173] op_sel:[0,0] op_sel_hi:[1,0]
    v_pk_mul_f32 v[22:23], v[22:23], v[78:79]
    v_lshlrev_b32 v72, 16, v148
    v_and_b32 v73, 0xffff0000, v148
    v_pk_add_f32 v[24:25], v[24:25], v[172:173] op_sel:[0,0] op_sel_hi:[1,0]
    v_pk_mul_f32 v[24:25], v[24:25], v[72:73]
    v_lshlrev_b32 v74, 16, v149
    v_and_b32 v75, 0xffff0000, v149
    v_pk_add_f32 v[26:27], v[26:27], v[172:173] op_sel:[0,0] op_sel_hi:[1,0]
    v_pk_mul_f32 v[26:27], v[26:27], v[74:75]
    v_lshlrev_b32 v76, 16, v150
    v_and_b32 v77, 0xffff0000, v150
    v_pk_add_f32 v[28:29], v[28:29], v[172:173] op_sel:[0,0] op_sel_hi:[1,0]
    v_pk_mul_f32 v[28:29], v[28:29], v[76:77]
    v_lshlrev_b32 v78, 16, v151
    v_and_b32 v79, 0xffff0000, v151
    v_pk_add_f32 v[30:31], v[30:31], v[172:173] op_sel:[0,0] op_sel_hi:[1,0]
    v_pk_mul_f32 v[30:31], v[30:31], v[78:79]
    v_lshlrev_b32 v72, 16, v152
    v_and_b32 v73, 0xffff0000, v152
    v_pk_add_f32 v[32:33], v[32:33], v[172:173] op_sel:[0,0] op_sel_hi:[1,0]
    v_pk_mul_f32 v[32:33], v[32:33], v[72:73]
    v_lshlrev_b32 v74, 16, v153
    v_and_b32 v75, 0xffff0000, v153
    v_pk_add_f32 v[34:35], v[34:35], v[172:173] op_sel:[0,0] op_sel_hi:[1,0]
    v_pk_mul_f32 v[34:35], v[34:35], v[74:75]
    v_lshlrev_b32 v76, 16, v154
    v_and_b32 v77, 0xffff0000, v154
    v_pk_add_f32 v[36:37], v[36:37], v[172:173] op_sel:[0,0] op_sel_hi:[1,0]
    v_pk_mul_f32 v[36:37], v[36:37], v[76:77]
    v_lshlrev_b32 v78, 16, v155
    v_and_b32 v79, 0xffff0000, v155
    v_pk_add_f32 v[38:39], v[38:39], v[172:173] op_sel:[0,0] op_sel_hi:[1,0]
    v_pk_mul_f32 v[38:39], v[38:39], v[78:79]
    v_lshlrev_b32 v72, 16, v156
    v_and_b32 v73, 0xffff0000, v156
    v_pk_add_f32 v[40:41], v[40:41], v[172:173] op_sel:[0,0] op_sel_hi:[1,0]
    v_pk_mul_f32 v[40:41], v[40:41], v[72:73]
    v_lshlrev_b32 v74, 16, v157
    v_and_b32 v75, 0xffff0000, v157
    v_pk_add_f32 v[42:43], v[42:43], v[172:173] op_sel:[0,0] op_sel_hi:[1,0]
    v_pk_mul_f32 v[42:43], v[42:43], v[74:75]
    v_lshlrev_b32 v72, 16, v158
    v_and_b32 v73, 0xffff0000, v158
    v_pk_add_f32 v[44:45], v[44:45], v[172:173] op_sel:[0,1] op_sel_hi:[1,1]
    v_pk_mul_f32 v[44:45], v[44:45], v[72:73]
    v_lshlrev_b32 v74, 16, v159
    v_and_b32 v75, 0xffff0000, v159
    v_pk_add_f32 v[46:47], v[46:47], v[172:173] op_sel:[0,1] op_sel_hi:[1,1]
    v_pk_mul_f32 v[46:47], v[46:47], v[74:75]
    v_lshlrev_b32 v76, 16, v160
    v_and_b32 v77, 0xffff0000, v160
    v_pk_add_f32 v[48:49], v[48:49], v[172:173] op_sel:[0,1] op_sel_hi:[1,1]
    v_pk_mul_f32 v[48:49], v[48:49], v[76:77]
    v_lshlrev_b32 v78, 16, v161
    v_and_b32 v79, 0xffff0000, v161
    v_pk_add_f32 v[50:51], v[50:51], v[172:173] op_sel:[0,1] op_sel_hi:[1,1]
    v_pk_mul_f32 v[50:51], v[50:51], v[78:79]
    v_lshlrev_b32 v72, 16, v162
    v_and_b32 v73, 0xffff0000, v162
    v_pk_add_f32 v[52:53], v[52:53], v[172:173] op_sel:[0,1] op_sel_hi:[1,1]
    v_pk_mul_f32 v[52:53], v[52:53], v[72:73]
    v_lshlrev_b32 v74, 16, v163
    v_and_b32 v75, 0xffff0000, v163
    v_pk_add_f32 v[54:55], v[54:55], v[172:173] op_sel:[0,1] op_sel_hi:[1,1]
    v_pk_mul_f32 v[54:55], v[54:55], v[74:75]
    v_lshlrev_b32 v76, 16, v164
    v_and_b32 v77, 0xffff0000, v164
    v_pk_add_f32 v[56:57], v[56:57], v[172:173] op_sel:[0,1] op_sel_hi:[1,1]
    v_pk_mul_f32 v[56:57], v[56:57], v[76:77]
    v_lshlrev_b32 v78, 16, v165
    v_and_b32 v79, 0xffff0000, v165
    v_pk_add_f32 v[58:59], v[58:59], v[172:173] op_sel:[0,1] op_sel_hi:[1,1]
    v_pk_mul_f32 v[58:59], v[58:59], v[78:79]
    v_lshlrev_b32 v72, 16, v166
    v_and_b32 v73, 0xffff0000, v166
    v_pk_add_f32 v[60:61], v[60:61], v[172:173] op_sel:[0,1] op_sel_hi:[1,1]
    v_pk_mul_f32 v[60:61], v[60:61], v[72:73]
    v_lshlrev_b32 v74, 16, v167
    v_and_b32 v75, 0xffff0000, v167
    v_pk_add_f32 v[62:63], v[62:63], v[172:173] op_sel:[0,1] op_sel_hi:[1,1]
    v_pk_mul_f32 v[62:63], v[62:63], v[74:75]
    v_lshlrev_b32 v76, 16, v168
    v_and_b32 v77, 0xffff0000, v168
    v_pk_add_f32 v[64:65], v[64:65], v[172:173] op_sel:[0,1] op_sel_hi:[1,1]
    v_pk_mul_f32 v[64:65], v[64:65], v[76:77]
    v_lshlrev_b32 v78, 16, v169
    v_and_b32 v79, 0xffff0000, v169
    v_pk_add_f32 v[66:67], v[66:67], v[172:173] op_sel:[0,1] op_sel_hi:[1,1]
    v_pk_mul_f32 v[66:67], v[66:67], v[78:79]
    v_lshlrev_b32 v72, 16, v170
    v_and_b32 v73, 0xffff0000, v170
    v_pk_add_f32 v[68:69], v[68:69], v[172:173] op_sel:[0,1] op_sel_hi:[1,1]
    v_pk_mul_f32 v[68:69], v[68:69], v[72:73]
    v_lshlrev_b32 v74, 16, v171
    v_and_b32 v75, 0xffff0000, v171
    v_pk_add_f32 v[70:71], v[70:71], v[172:173] op_sel:[0,1] op_sel_hi:[1,1]
    v_pk_mul_f32 v[70:71], v[70:71], v[74:75]
C_PACK:
    v_cvt_pk_bf16_f32 v108, v16, v17
    v_cvt_pk_bf16_f32 v109, v18, v19
    v_cvt_pk_bf16_f32 v110, v20, v21
    v_cvt_pk_bf16_f32 v111, v22, v23
    v_cvt_pk_bf16_f32 v112, v24, v25
    v_cvt_pk_bf16_f32 v113, v26, v27
    v_cvt_pk_bf16_f32 v114, v28, v29
    v_cvt_pk_bf16_f32 v115, v30, v31
    v_cvt_pk_bf16_f32 v116, v32, v33
    v_cvt_pk_bf16_f32 v117, v34, v35
    v_cvt_pk_bf16_f32 v118, v36, v37
    v_cvt_pk_bf16_f32 v119, v38, v39
    v_cvt_pk_bf16_f32 v120, v40, v41
    v_cvt_pk_bf16_f32 v121, v42, v43
    buffer_store_dwordx4 v[108:111], v14, s[32:35], s66 offen offset:0 sc0 sc1
    buffer_store_dwordx4 v[112:115], v14, s[32:35], s66 offen offset:1024 sc0 sc1
    buffer_store_dwordx4 v[116:119], v14, s[32:35], s66 offen offset:2048 sc0 sc1
    buffer_store_dwordx2 v[120:121], v15, s[32:35], s66 offen offset:3072 sc0 sc1
    v_cvt_pk_bf16_f32 v124, v44, v45
    v_cvt_pk_bf16_f32 v125, v46, v47
    v_cvt_pk_bf16_f32 v126, v48, v49
    v_cvt_pk_bf16_f32 v127, v50, v51
    v_cvt_pk_bf16_f32 v128, v52, v53
    v_cvt_pk_bf16_f32 v129, v54, v55
    v_cvt_pk_bf16_f32 v130, v56, v57
    v_cvt_pk_bf16_f32 v131, v58, v59
    v_cvt_pk_bf16_f32 v132, v60, v61
    v_cvt_pk_bf16_f32 v133, v62, v63
    v_cvt_pk_bf16_f32 v134, v64, v65
    v_cvt_pk_bf16_f32 v135, v66, v67
    v_cvt_pk_bf16_f32 v136, v68, v69
    v_cvt_pk_bf16_f32 v137, v70, v71
    buffer_store_dwordx4 v[124:127], v14, s[32:35], s67 offen offset:0 sc0 sc1
    buffer_store_dwordx4 v[128:131], v14, s[32:35], s67 offen offset:1024 sc0 sc1
    buffer_store_dwordx4 v[132:135], v14, s[32:35], s67 offen offset:2048 sc0 sc1
    buffer_store_dwordx2 v[136:137], v15, s[32:35], s67 offen offset:3072 sc0 sc1
    s_lshl_b32 s40, s58, 3
    s_lshr_b32 s41, s59, 2
    s_add_u32 s40, s40, s41
    s_and_b32 s41, s59, 3
    s_mul_i32 s42, s41, 196
    s_mul_i32 s43, s3, 7
    s_add_u32 s42, s42, s43
    s_lshl_b32 s42, s42, 10
    s_add_u32 s42, s42, 20971520
    v_lshlrev_b32 v14, 4, v2
    s_add_u32 s43, s42, 0
    buffer_load_dwordx4 v[144:147], v14, s[32:35], s43 offen offset:0 sc1
    buffer_load_dwordx4 v[148:151], v14, s[32:35], s43 offen offset:1024 sc1
    buffer_load_dwordx4 v[152:155], v14, s[32:35], s43 offen offset:2048 sc1
    buffer_load_dwordx4 v[156:159], v14, s[32:35], s43 offen offset:3072 sc1
    s_add_u32 s43, s42, 4096
    buffer_load_dwordx4 v[160:163], v14, s[32:35], s43 offen offset:0 sc1
    buffer_load_dwordx4 v[164:167], v14, s[32:35], s43 offen offset:1024 sc1
    buffer_load_dwordx4 v[168:171], v14, s[32:35], s43 offen offset:2048 sc1
    s_add_u32 s43, s42, 50176
    buffer_load_dwordx4 v[172:175], v14, s[32:35], s43 offen offset:0 sc1
    s_lshl_b32 s74, s57, 13
    s_lshl_b32 s75, s72, 7
    s_add_u32 s74, s74, s75
    s_add_u32 s74, s74, 22249472
    v_mov_b32 v3, 0
    v_mov_b32 v4, 1
    s_waitcnt vmcnt(8)
    s_mov_b64 exec, 1
    buffer_store_dword v4, v3, s[32:35], s74 offen sc0 sc1
    s_mov_b64 exec, -1
P3:
    v_lshlrev_b32 v15, 3, v2
    s_cmp_ge_u32 s3, 3
    s_cselect_b32 s44, 1, 0
    s_mul_i32 s45, s44, 3
    s_sub_u32 s45, s3, s45
    s_lshl_b32 s45, s45, 10
    s_cmp_eq_u32 s3, 6
    s_cselect_b32 s44, 0, s44
    s_lshl_b32 s46, s40, 4
    s_add_u32 s44, s44, s46
    s_mul_i32 s44, s44, 3584
    s_add_u32 s44, s44, s45
    s_add_u32 s44, s44, 12582912
    s_and_b32 s45, s3, 1
    s_lshr_b32 s46, s3, 1
    s_lshl_b32 s47, s40, 1
    s_add_u32 s47, s47, s45
    s_lshl_b32 s47, s47, 2
    s_add_u32 s47, s47, s41
    s_mul_i32 s47, s47, 3584
    s_lshl_b32 s48, s46, 10
    s_add_u32 s47, s47, s48
    s_add_u32 s47, s47, 16777216
    s_add_u32 s48, s47, 1835008
    v_and_b32 v3, 12, v2
    v_and_b32 v4, 3, v2
    v_lshl_or_b32 v3, v3, 1, v4
    s_lshl_b32 s49, s40, 5
    s_lshl_b32 s50, s45, 2
    s_add_u32 s49, s49, s50
    v_add_u32 v3, s49, v3
    v_lshlrev_b32 v5, 2, v3
    v_mul_u32_u24 v6, 896, v3
    v_lshrrev_b32 v4, 4, v2
    v_lshl_add_u32 v7, v4, 4, v6
    v_lshl_add_u32 v8, v4, 3, v6
    s_mul_i32 s49, s41, 224
    s_lshl_b32 s50, s46, 6
    s_add_u32 s49, s49, s50
    s_mov_b32 s50, 22020096
    s_mov_b32 s52, s26
    s_and_b32 s53, s27, 0xffff
    s_mov_b32 s54, 1835008
    s_mov_b32 s55, 0x20000
    s_mul_i32 s51, s3, 14336
    v_add_u32 v9, s51, v14
    s_mul_i32 s51, s45, 7168
    s_lshl_b32 s60, s46, 11
    s_add_u32 s51, s51, s60
    v_add_u32 v10, s51, v14
    v_add_u32 v11, 0xe000, v10
    s_barrier
    s_cmp_eq_u32 s3, 6
    s_cbranch_scc1 P3_L6
    s_add_u32 s60, s44, 0
    buffer_load_dwordx4 v[72:75], v14, s[32:35], s60 offen sc1
    s_add_u32 s60, s44, 28672
    buffer_load_dwordx4 v[76:79], v14, s[32:35], s60 offen sc1
    s_add_u32 s60, s44, 7168
    buffer_load_dwordx4 v[80:83], v14, s[32:35], s60 offen sc1
    s_add_u32 s60, s44, 35840
    buffer_load_dwordx4 v[84:87], v14, s[32:35], s60 offen sc1
    s_add_u32 s60, s44, 14336
    buffer_load_dwordx4 v[88:91], v14, s[32:35], s60 offen sc1
    s_add_u32 s60, s44, 43008
    buffer_load_dwordx4 v[92:95], v14, s[32:35], s60 offen sc1
    s_add_u32 s60, s44, 21504
    buffer_load_dwordx4 v[96:99], v14, s[32:35], s60 offen sc1
    s_add_u32 s60, s44, 50176
    buffer_load_dwordx4 v[100:103], v14, s[32:35], s60 offen sc1
    buffer_load_dwordx4 v[104:107], v14, s[32:35], s47 offen sc1
    buffer_load_dwordx4 v[108:111], v14, s[32:35], s48 offen sc1
    buffer_load_dword v112, v5, s[32:35], s50 offen sc1
    s_waitcnt vmcnt(9)
    v_mfma_f32_16x16x32_bf16 v[16:19], v[144:147], v[72:75], 0
    v_mfma_f32_16x16x32_bf16 v[44:47], v[144:147], v[76:79], 0
    v_mfma_f32_16x16x32_bf16 v[20:23], v[148:151], v[72:75], 0
    v_mfma_f32_16x16x32_bf16 v[48:51], v[148:151], v[76:79], 0
    v_mfma_f32_16x16x32_bf16 v[24:27], v[152:155], v[72:75], 0
    v_mfma_f32_16x16x32_bf16 v[52:55], v[152:155], v[76:79], 0
    v_mfma_f32_16x16x32_bf16 v[28:31], v[156:159], v[72:75], 0
    v_mfma_f32_16x16x32_bf16 v[56:59], v[156:159], v[76:79], 0
    v_mfma_f32_16x16x32_bf16 v[32:35], v[160:163], v[72:75], 0
    v_mfma_f32_16x16x32_bf16 v[60:63], v[160:163], v[76:79], 0
    v_mfma_f32_16x16x32_bf16 v[36:39], v[164:167], v[72:75], 0
    v_mfma_f32_16x16x32_bf16 v[64:67], v[164:167], v[76:79], 0
    v_mfma_f32_16x16x32_bf16 v[40:43], v[168:171], v[72:75], 0
    v_mfma_f32_16x16x32_bf16 v[68:71], v[168:171], v[76:79], 0
    s_waitcnt vmcnt(7)
    v_mfma_f32_16x16x32_bf16 v[16:19], v[172:175], v[80:83], v[16:19]
    v_mfma_f32_16x16x32_bf16 v[44:47], v[172:175], v[84:87], v[44:47]
    v_mfma_f32_16x16x32_bf16 v[20:23], v[176:179], v[80:83], v[20:23]
    v_mfma_f32_16x16x32_bf16 v[48:51], v[176:179], v[84:87], v[48:51]
    v_mfma_f32_16x16x32_bf16 v[24:27], v[180:183], v[80:83], v[24:27]
    v_mfma_f32_16x16x32_bf16 v[52:55], v[180:183], v[84:87], v[52:55]
    v_mfma_f32_16x16x32_bf16 v[28:31], v[184:187], v[80:83], v[28:31]
    v_mfma_f32_16x16x32_bf16 v[56:59], v[184:187], v[84:87], v[56:59]
    v_mfma_f32_16x16x32_bf16 v[32:35], v[188:191], v[80:83], v[32:35]
    v_mfma_f32_16x16x32_bf16 v[60:63], v[188:191], v[84:87], v[60:63]
    v_mfma_f32_16x16x32_bf16 v[36:39], v[192:195], v[80:83], v[36:39]
    v_mfma_f32_16x16x32_bf16 v[64:67], v[192:195], v[84:87], v[64:67]
    v_mfma_f32_16x16x32_bf16 v[40:43], v[196:199], v[80:83], v[40:43]
    v_mfma_f32_16x16x32_bf16 v[68:71], v[196:199], v[84:87], v[68:71]
    s_waitcnt vmcnt(5)
    v_mfma_f32_16x16x32_bf16 v[16:19], v[200:203], v[88:91], v[16:19]
    v_mfma_f32_16x16x32_bf16 v[44:47], v[200:203], v[92:95], v[44:47]
    v_mfma_f32_16x16x32_bf16 v[20:23], v[204:207], v[88:91], v[20:23]
    v_mfma_f32_16x16x32_bf16 v[48:51], v[204:207], v[92:95], v[48:51]
    v_mfma_f32_16x16x32_bf16 v[24:27], v[208:211], v[88:91], v[24:27]
    v_mfma_f32_16x16x32_bf16 v[52:55], v[208:211], v[92:95], v[52:55]
    v_mfma_f32_16x16x32_bf16 v[28:31], v[212:215], v[88:91], v[28:31]
    v_mfma_f32_16x16x32_bf16 v[56:59], v[212:215], v[92:95], v[56:59]
    v_mfma_f32_16x16x32_bf16 v[32:35], v[216:219], v[88:91], v[32:35]
    v_mfma_f32_16x16x32_bf16 v[60:63], v[216:219], v[92:95], v[60:63]
    v_mfma_f32_16x16x32_bf16 v[36:39], v[220:223], v[88:91], v[36:39]
    v_mfma_f32_16x16x32_bf16 v[64:67], v[220:223], v[92:95], v[64:67]
    v_mfma_f32_16x16x32_bf16 v[40:43], v[224:227], v[88:91], v[40:43]
    v_mfma_f32_16x16x32_bf16 v[68:71], v[224:227], v[92:95], v[68:71]
    s_waitcnt vmcnt(3)
    v_mfma_f32_16x16x32_bf16 v[16:19], v[228:231], v[96:99], v[16:19]
    v_mfma_f32_16x16x32_bf16 v[44:47], v[228:231], v[100:103], v[44:47]
    v_mfma_f32_16x16x32_bf16 v[20:23], v[232:235], v[96:99], v[20:23]
    v_mfma_f32_16x16x32_bf16 v[48:51], v[232:235], v[100:103], v[48:51]
    v_mfma_f32_16x16x32_bf16 v[24:27], v[236:239], v[96:99], v[24:27]
    v_mfma_f32_16x16x32_bf16 v[52:55], v[236:239], v[100:103], v[52:55]
    v_mfma_f32_16x16x32_bf16 v[28:31], v[240:243], v[96:99], v[28:31]
    v_mfma_f32_16x16x32_bf16 v[56:59], v[240:243], v[100:103], v[56:59]
    v_mfma_f32_16x16x32_bf16 v[32:35], v[244:247], v[96:99], v[32:35]
    v_mfma_f32_16x16x32_bf16 v[60:63], v[244:247], v[100:103], v[60:63]
    v_mfma_f32_16x16x32_bf16 v[36:39], v[248:251], v[96:99], v[36:39]
    v_mfma_f32_16x16x32_bf16 v[64:67], v[248:251], v[100:103], v[64:67]
    v_mfma_f32_16x16x32_bf16 v[40:43], v[252:255], v[96:99], v[40:43]
    v_mfma_f32_16x16x32_bf16 v[68:71], v[252:255], v[100:103], v[68:71]
    s_branch P3_R
P3_L6:
    s_add_u32 s60, s44, 0
    buffer_load_dwordx2 v[72:73], v15, s[32:35], s60 offen offset:0 sc1
    buffer_load_dwordx2 v[74:75], v15, s[32:35], s60 offen offset:3584 sc1
    s_add_u32 s60, s44, 28672
    buffer_load_dwordx2 v[76:77], v15, s[32:35], s60 offen offset:0 sc1
    buffer_load_dwordx2 v[78:79], v15, s[32:35], s60 offen offset:3584 sc1
    s_add_u32 s60, s44, 7168
    buffer_load_dwordx2 v[80:81], v15, s[32:35], s60 offen offset:0 sc1
    buffer_load_dwordx2 v[82:83], v15, s[32:35], s60 offen offset:3584 sc1
    s_add_u32 s60, s44, 35840
    buffer_load_dwordx2 v[84:85], v15, s[32:35], s60 offen offset:0 sc1
    buffer_load_dwordx2 v[86:87], v15, s[32:35], s60 offen offset:3584 sc1
    s_add_u32 s60, s44, 14336
    buffer_load_dwordx2 v[88:89], v15, s[32:35], s60 offen offset:0 sc1
    buffer_load_dwordx2 v[90:91], v15, s[32:35], s60 offen offset:3584 sc1
    s_add_u32 s60, s44, 43008
    buffer_load_dwordx2 v[92:93], v15, s[32:35], s60 offen offset:0 sc1
    buffer_load_dwordx2 v[94:95], v15, s[32:35], s60 offen offset:3584 sc1
    s_add_u32 s60, s44, 21504
    buffer_load_dwordx2 v[96:97], v15, s[32:35], s60 offen offset:0 sc1
    buffer_load_dwordx2 v[98:99], v15, s[32:35], s60 offen offset:3584 sc1
    s_add_u32 s60, s44, 50176
    buffer_load_dwordx2 v[100:101], v15, s[32:35], s60 offen offset:0 sc1
    buffer_load_dwordx2 v[102:103], v15, s[32:35], s60 offen offset:3584 sc1
    s_add_u32 s60, s47, 0
    buffer_load_dwordx2 v[104:105], v15, s[32:35], s60 offen sc1
    s_add_u32 s60, s47, 14336
    buffer_load_dwordx2 v[106:107], v15, s[32:35], s60 offen sc1
    s_add_u32 s60, s48, 0
    buffer_load_dwordx2 v[108:109], v15, s[32:35], s60 offen sc1
    s_add_u32 s60, s48, 14336
    buffer_load_dwordx2 v[110:111], v15, s[32:35], s60 offen sc1
    buffer_load_dword v112, v5, s[32:35], s50 offen sc1
    buffer_load_dword v114, v5, s[32:35], s50 offen offset:16 sc1
    s_waitcnt vmcnt(18)
    v_mfma_f32_16x16x32_bf16 v[16:19], v[144:147], v[72:75], 0
    v_mfma_f32_16x16x32_bf16 v[44:47], v[144:147], v[76:79], 0
    v_mfma_f32_16x16x32_bf16 v[20:23], v[148:151], v[72:75], 0
    v_mfma_f32_16x16x32_bf16 v[48:51], v[148:151], v[76:79], 0
    v_mfma_f32_16x16x32_bf16 v[24:27], v[152:155], v[72:75], 0
    v_mfma_f32_16x16x32_bf16 v[52:55], v[152:155], v[76:79], 0
    v_mfma_f32_16x16x32_bf16 v[28:31], v[156:159], v[72:75], 0
    v_mfma_f32_16x16x32_bf16 v[56:59], v[156:159], v[76:79], 0
    v_mfma_f32_16x16x32_bf16 v[32:35], v[160:163], v[72:75], 0
    v_mfma_f32_16x16x32_bf16 v[60:63], v[160:163], v[76:79], 0
    v_mfma_f32_16x16x32_bf16 v[36:39], v[164:167], v[72:75], 0
    v_mfma_f32_16x16x32_bf16 v[64:67], v[164:167], v[76:79], 0
    v_mfma_f32_16x16x32_bf16 v[40:43], v[168:171], v[72:75], 0
    v_mfma_f32_16x16x32_bf16 v[68:71], v[168:171], v[76:79], 0
    s_waitcnt vmcnt(14)
    v_mfma_f32_16x16x32_bf16 v[16:19], v[172:175], v[80:83], v[16:19]
    v_mfma_f32_16x16x32_bf16 v[44:47], v[172:175], v[84:87], v[44:47]
    v_mfma_f32_16x16x32_bf16 v[20:23], v[176:179], v[80:83], v[20:23]
    v_mfma_f32_16x16x32_bf16 v[48:51], v[176:179], v[84:87], v[48:51]
    v_mfma_f32_16x16x32_bf16 v[24:27], v[180:183], v[80:83], v[24:27]
    v_mfma_f32_16x16x32_bf16 v[52:55], v[180:183], v[84:87], v[52:55]
    v_mfma_f32_16x16x32_bf16 v[28:31], v[184:187], v[80:83], v[28:31]
    v_mfma_f32_16x16x32_bf16 v[56:59], v[184:187], v[84:87], v[56:59]
    v_mfma_f32_16x16x32_bf16 v[32:35], v[188:191], v[80:83], v[32:35]
    v_mfma_f32_16x16x32_bf16 v[60:63], v[188:191], v[84:87], v[60:63]
    v_mfma_f32_16x16x32_bf16 v[36:39], v[192:195], v[80:83], v[36:39]
    v_mfma_f32_16x16x32_bf16 v[64:67], v[192:195], v[84:87], v[64:67]
    v_mfma_f32_16x16x32_bf16 v[40:43], v[196:199], v[80:83], v[40:43]
    v_mfma_f32_16x16x32_bf16 v[68:71], v[196:199], v[84:87], v[68:71]
    s_waitcnt vmcnt(10)
    v_mfma_f32_16x16x32_bf16 v[16:19], v[200:203], v[88:91], v[16:19]
    v_mfma_f32_16x16x32_bf16 v[44:47], v[200:203], v[92:95], v[44:47]
    v_mfma_f32_16x16x32_bf16 v[20:23], v[204:207], v[88:91], v[20:23]
    v_mfma_f32_16x16x32_bf16 v[48:51], v[204:207], v[92:95], v[48:51]
    v_mfma_f32_16x16x32_bf16 v[24:27], v[208:211], v[88:91], v[24:27]
    v_mfma_f32_16x16x32_bf16 v[52:55], v[208:211], v[92:95], v[52:55]
    v_mfma_f32_16x16x32_bf16 v[28:31], v[212:215], v[88:91], v[28:31]
    v_mfma_f32_16x16x32_bf16 v[56:59], v[212:215], v[92:95], v[56:59]
    v_mfma_f32_16x16x32_bf16 v[32:35], v[216:219], v[88:91], v[32:35]
    v_mfma_f32_16x16x32_bf16 v[60:63], v[216:219], v[92:95], v[60:63]
    v_mfma_f32_16x16x32_bf16 v[36:39], v[220:223], v[88:91], v[36:39]
    v_mfma_f32_16x16x32_bf16 v[64:67], v[220:223], v[92:95], v[64:67]
    v_mfma_f32_16x16x32_bf16 v[40:43], v[224:227], v[88:91], v[40:43]
    v_mfma_f32_16x16x32_bf16 v[68:71], v[224:227], v[92:95], v[68:71]
    s_waitcnt vmcnt(6)
    v_mfma_f32_16x16x32_bf16 v[16:19], v[228:231], v[96:99], v[16:19]
    v_mfma_f32_16x16x32_bf16 v[44:47], v[228:231], v[100:103], v[44:47]
    v_mfma_f32_16x16x32_bf16 v[20:23], v[232:235], v[96:99], v[20:23]
    v_mfma_f32_16x16x32_bf16 v[48:51], v[232:235], v[100:103], v[48:51]
    v_mfma_f32_16x16x32_bf16 v[24:27], v[236:239], v[96:99], v[24:27]
    v_mfma_f32_16x16x32_bf16 v[52:55], v[236:239], v[100:103], v[52:55]
    v_mfma_f32_16x16x32_bf16 v[28:31], v[240:243], v[96:99], v[28:31]
    v_mfma_f32_16x16x32_bf16 v[56:59], v[240:243], v[100:103], v[56:59]
    v_mfma_f32_16x16x32_bf16 v[32:35], v[244:247], v[96:99], v[32:35]
    v_mfma_f32_16x16x32_bf16 v[60:63], v[244:247], v[100:103], v[60:63]
    v_mfma_f32_16x16x32_bf16 v[36:39], v[248:251], v[96:99], v[36:39]
    v_mfma_f32_16x16x32_bf16 v[64:67], v[248:251], v[100:103], v[64:67]
    v_mfma_f32_16x16x32_bf16 v[40:43], v[252:255], v[96:99], v[40:43]
    v_mfma_f32_16x16x32_bf16 v[68:71], v[252:255], v[100:103], v[68:71]
P3_R:
    s_nop 4
    ds_write_b128 v9, v[16:19] offset:0
    ds_write_b128 v9, v[20:23] offset:1024
    ds_write_b128 v9, v[24:27] offset:2048
    ds_write_b128 v9, v[28:31] offset:3072
    ds_write_b128 v9, v[32:35] offset:4096
    ds_write_b128 v9, v[36:39] offset:5120
    ds_write_b128 v9, v[40:43] offset:6144
    ds_write_b128 v9, v[44:47] offset:7168
    ds_write_b128 v9, v[48:51] offset:8192
    ds_write_b128 v9, v[52:55] offset:9216
    ds_write_b128 v9, v[56:59] offset:10240
    ds_write_b128 v9, v[60:63] offset:11264
    ds_write_b128 v9, v[64:67] offset:12288
    ds_write_b128 v9, v[68:71] offset:13312
    s_waitcnt lgkmcnt(0)
    s_barrier
    s_cmp_eq_u32 s3, 6
    s_cbranch_scc1 P3_F6
    ds_read_b128 v[144:147], v10 offset:0
    ds_read_b128 v[148:151], v10 offset:14336
    ds_read_b128 v[152:155], v10 offset:28672
    ds_read_b128 v[156:159], v10 offset:43008
    ds_read_b128 v[160:163], v11 offset:0
    ds_read_b128 v[164:167], v11 offset:14336
    ds_read_b128 v[168:171], v11 offset:28672
    ds_read_b128 v[172:175], v10 offset:1024
    ds_read_b128 v[176:179], v10 offset:15360
    ds_read_b128 v[180:183], v10 offset:29696
    ds_read_b128 v[184:187], v10 offset:44032
    ds_read_b128 v[188:191], v11 offset:1024
    ds_read_b128 v[192:195], v11 offset:15360
    ds_read_b128 v[196:199], v11 offset:29696
    s_waitcnt vmcnt(0)
    v_sub_f32 v113, 1.0, v112
    s_waitcnt lgkmcnt(7)
    v_pk_add_f32 v[148:149], v[148:149], v[152:153]
    v_pk_add_f32 v[150:151], v[150:151], v[154:155]
    v_pk_add_f32 v[156:157], v[156:157], v[160:161]
    v_pk_add_f32 v[158:159], v[158:159], v[162:163]
    v_pk_add_f32 v[164:165], v[164:165], v[168:169]
    v_pk_add_f32 v[166:167], v[166:167], v[170:171]
    v_pk_add_f32 v[144:145], v[144:145], v[148:149]
    v_pk_add_f32 v[146:147], v[146:147], v[150:151]
    v_pk_add_f32 v[156:157], v[156:157], v[164:165]
    v_pk_add_f32 v[158:159], v[158:159], v[166:167]
    v_pk_add_f32 v[144:145], v[144:145], v[156:157]
    v_pk_add_f32 v[146:147], v[146:147], v[158:159]
    v_lshlrev_b32 v148, 16, v104
    v_and_b32 v149, 0xffff0000, v104
    v_lshlrev_b32 v152, 16, v108
    v_and_b32 v153, 0xffff0000, v108
    v_lshlrev_b32 v150, 16, v105
    v_and_b32 v151, 0xffff0000, v105
    v_lshlrev_b32 v154, 16, v109
    v_and_b32 v155, 0xffff0000, v109
    v_sub_f32 v148, v148, v152
    v_mul_f32 v144, v144, v113
    v_sub_f32 v149, v149, v153
    v_mul_f32 v145, v145, v113
    v_sub_f32 v150, v150, v154
    v_mul_f32 v146, v146, v113
    v_sub_f32 v151, v151, v155
    v_mul_f32 v147, v147, v113
    v_fmac_f32 v144, v148, v112
    v_fmac_f32 v145, v149, v112
    v_fmac_f32 v146, v150, v112
    v_fmac_f32 v147, v151, v112
    v_cvt_pk_bf16_f32 v116, v144, v145
    v_cvt_pk_bf16_f32 v117, v146, v147
    s_waitcnt lgkmcnt(0)
    v_pk_add_f32 v[176:177], v[176:177], v[180:181]
    v_pk_add_f32 v[178:179], v[178:179], v[182:183]
    v_pk_add_f32 v[184:185], v[184:185], v[188:189]
    v_pk_add_f32 v[186:187], v[186:187], v[190:191]
    v_pk_add_f32 v[192:193], v[192:193], v[196:197]
    v_pk_add_f32 v[194:195], v[194:195], v[198:199]
    v_pk_add_f32 v[172:173], v[172:173], v[176:177]
    v_pk_add_f32 v[174:175], v[174:175], v[178:179]
    v_pk_add_f32 v[184:185], v[184:185], v[192:193]
    v_pk_add_f32 v[186:187], v[186:187], v[194:195]
    v_pk_add_f32 v[172:173], v[172:173], v[184:185]
    v_pk_add_f32 v[174:175], v[174:175], v[186:187]
    v_lshlrev_b32 v176, 16, v106
    v_and_b32 v177, 0xffff0000, v106
    v_lshlrev_b32 v180, 16, v110
    v_and_b32 v181, 0xffff0000, v110
    v_lshlrev_b32 v178, 16, v107
    v_and_b32 v179, 0xffff0000, v107
    v_lshlrev_b32 v182, 16, v111
    v_and_b32 v183, 0xffff0000, v111
    v_sub_f32 v176, v176, v180
    v_mul_f32 v172, v172, v113
    v_sub_f32 v177, v177, v181
    v_mul_f32 v173, v173, v113
    v_sub_f32 v178, v178, v182
    v_mul_f32 v174, v174, v113
    v_sub_f32 v179, v179, v183
    v_mul_f32 v175, v175, v113
    v_fmac_f32 v172, v176, v112
    v_fmac_f32 v173, v177, v112
    v_fmac_f32 v174, v178, v112
    v_fmac_f32 v175, v179, v112
    v_cvt_pk_bf16_f32 v118, v172, v173
    v_cvt_pk_bf16_f32 v119, v174, v175
    buffer_store_dwordx4 v[116:119], v7, s[52:55], s49 offen
    s_endpgm
P3_F6:
    ds_read_b128 v[144:147], v10 offset:0
    ds_read_b128 v[148:151], v10 offset:14336
    ds_read_b128 v[152:155], v10 offset:28672
    ds_read_b128 v[156:159], v10 offset:43008
    ds_read_b128 v[160:163], v11 offset:0
    ds_read_b128 v[164:167], v11 offset:14336
    ds_read_b128 v[168:171], v11 offset:28672
    ds_read_b128 v[172:175], v10 offset:7168
    ds_read_b128 v[176:179], v10 offset:21504
    ds_read_b128 v[180:183], v10 offset:35840
    ds_read_b128 v[184:187], v10 offset:50176
    ds_read_b128 v[188:191], v11 offset:7168
    ds_read_b128 v[192:195], v11 offset:21504
    ds_read_b128 v[196:199], v11 offset:35840
    s_waitcnt vmcnt(0)
    v_sub_f32 v113, 1.0, v112
    v_sub_f32 v115, 1.0, v114
    s_waitcnt lgkmcnt(7)
    v_pk_add_f32 v[148:149], v[148:149], v[152:153]
    v_pk_add_f32 v[150:151], v[150:151], v[154:155]
    v_pk_add_f32 v[156:157], v[156:157], v[160:161]
    v_pk_add_f32 v[158:159], v[158:159], v[162:163]
    v_pk_add_f32 v[164:165], v[164:165], v[168:169]
    v_pk_add_f32 v[166:167], v[166:167], v[170:171]
    v_pk_add_f32 v[144:145], v[144:145], v[148:149]
    v_pk_add_f32 v[146:147], v[146:147], v[150:151]
    v_pk_add_f32 v[156:157], v[156:157], v[164:165]
    v_pk_add_f32 v[158:159], v[158:159], v[166:167]
    v_pk_add_f32 v[144:145], v[144:145], v[156:157]
    v_pk_add_f32 v[146:147], v[146:147], v[158:159]
    v_lshlrev_b32 v148, 16, v104
    v_and_b32 v149, 0xffff0000, v104
    v_lshlrev_b32 v152, 16, v108
    v_and_b32 v153, 0xffff0000, v108
    v_lshlrev_b32 v150, 16, v105
    v_and_b32 v151, 0xffff0000, v105
    v_lshlrev_b32 v154, 16, v109
    v_and_b32 v155, 0xffff0000, v109
    v_sub_f32 v148, v148, v152
    v_mul_f32 v144, v144, v113
    v_sub_f32 v149, v149, v153
    v_mul_f32 v145, v145, v113
    v_sub_f32 v150, v150, v154
    v_mul_f32 v146, v146, v113
    v_sub_f32 v151, v151, v155
    v_mul_f32 v147, v147, v113
    v_fmac_f32 v144, v148, v112
    v_fmac_f32 v145, v149, v112
    v_fmac_f32 v146, v150, v112
    v_fmac_f32 v147, v151, v112
    v_cvt_pk_bf16_f32 v116, v144, v145
    v_cvt_pk_bf16_f32 v117, v146, v147
    s_waitcnt lgkmcnt(0)
    v_pk_add_f32 v[176:177], v[176:177], v[180:181]
    v_pk_add_f32 v[178:179], v[178:179], v[182:183]
    v_pk_add_f32 v[184:185], v[184:185], v[188:189]
    v_pk_add_f32 v[186:187], v[186:187], v[190:191]
    v_pk_add_f32 v[192:193], v[192:193], v[196:197]
    v_pk_add_f32 v[194:195], v[194:195], v[198:199]
    v_pk_add_f32 v[172:173], v[172:173], v[176:177]
    v_pk_add_f32 v[174:175], v[174:175], v[178:179]
    v_pk_add_f32 v[184:185], v[184:185], v[192:193]
    v_pk_add_f32 v[186:187], v[186:187], v[194:195]
    v_pk_add_f32 v[172:173], v[172:173], v[184:185]
    v_pk_add_f32 v[174:175], v[174:175], v[186:187]
    v_lshlrev_b32 v176, 16, v106
    v_and_b32 v177, 0xffff0000, v106
    v_lshlrev_b32 v180, 16, v110
    v_and_b32 v181, 0xffff0000, v110
    v_lshlrev_b32 v178, 16, v107
    v_and_b32 v179, 0xffff0000, v107
    v_lshlrev_b32 v182, 16, v111
    v_and_b32 v183, 0xffff0000, v111
    v_sub_f32 v176, v176, v180
    v_mul_f32 v172, v172, v115
    v_sub_f32 v177, v177, v181
    v_mul_f32 v173, v173, v115
    v_sub_f32 v178, v178, v182
    v_mul_f32 v174, v174, v115
    v_sub_f32 v179, v179, v183
    v_mul_f32 v175, v175, v115
    v_fmac_f32 v172, v176, v114
    v_fmac_f32 v173, v177, v114
    v_fmac_f32 v174, v178, v114
    v_fmac_f32 v175, v179, v114
    v_cvt_pk_bf16_f32 v118, v172, v173
    v_cvt_pk_bf16_f32 v119, v174, v175
    buffer_store_dwordx2 v[116:117], v8, s[52:55], s49 offen
    buffer_store_dwordx2 v[118:119], v8, s[52:55], s49 offen offset:3584
    s_endpgm
.section .rodata,"a"
.p2align 6
.amdhsa_kernel kf_kernel
  .amdhsa_next_free_vgpr 256
  .amdhsa_next_free_sgpr 100
  .amdhsa_accum_offset 256
  .amdhsa_group_segment_fixed_size 0
  .amdhsa_kernarg_size 112
  .amdhsa_user_sgpr_count 2
  .amdhsa_user_sgpr_kernarg_segment_ptr 1
  .amdhsa_system_sgpr_workgroup_id_x 1
.end_amdhsa_kernel
```
